```python
import torch

def _softmax(x, axis=-1):
    return torch.softmax(x, dim=axis)
def _gelu(x):
    return torch.nn.functional.gelu(x, approximate="tanh")
def _silu(x):
    return torch.nn.functional.silu(x)
def _sigmoid(x):
    return torch.sigmoid(x)
def _layernorm(x, axis=-1, eps=1e-5):
    m = x.mean(dim=axis, keepdim=True)
    v = x.var(dim=axis, keepdim=True, unbiased=False)
    return (x - m) / torch.sqrt(v + eps)
def _scatter_add(tgt, idx, src, axis=0):
    return tgt.clone().index_add_(axis, idx, src)
def _segment_sum(src, seg, n):
    out = torch.zeros((n,) + src.shape[1:], dtype=src.dtype)
    return out.index_add_(0, seg, src)
def _pad(x, pw):
    flat = tuple(v for pair in reversed(pw) for v in pair)
    return torch.nn.functional.pad(x, flat)

kernel_name = 'concat_heads__ssm_conv_s5__softmax_full_mha__prompt'

def setup_inputs():

    _w = (lambda a: (lambda t: t.to(torch.bfloat16) if t.is_floating_point() else t)(torch.as_tensor(a)))
    def _A_setup():
        B, S, D = 1, 2048, 640
        P = D
        Lambda_re = -0.5 * (lambda _x: torch.exp(torch.as_tensor(_x)))((lambda *s: torch.randn(*s, dtype=torch.bfloat16) * 0.8)(P))
        Lambda_im = (lambda *s: torch.randn(*s, dtype=torch.bfloat16) * 0.8)(P) * 1.0
        B_re = (lambda *s: torch.randn(*s, dtype=torch.bfloat16) * 0.8)(P, D) * (D ** -0.5)
        B_im = (lambda *s: torch.randn(*s, dtype=torch.bfloat16) * 0.8)(P, D) * (D ** -0.5)
        C_re = (lambda *s: torch.randn(*s, dtype=torch.bfloat16) * 0.8)(D, P) * (P ** -0.5)
        C_im = (lambda *s: torch.randn(*s, dtype=torch.bfloat16) * 0.8)(D, P) * (P ** -0.5)
        log_dt = (lambda *s: torch.randn(*s, dtype=torch.bfloat16) * 0.8)(P) * 0.3 - 2.0
        Dskip = (lambda *s: torch.randn(*s, dtype=torch.bfloat16) * 0.8)(D)
        return {
            "x": _w((lambda *s: torch.randn(*s, dtype=torch.bfloat16) * 0.05)(B, S, D)),
            "Lambda_re": _w(Lambda_re),
            "Lambda_im": _w(Lambda_im),
            "B_re": _w(B_re),
            "B_im": _w(B_im),
            "C_re": _w(C_re),
            "C_im": _w(C_im),
            "log_dt": _w(log_dt),
            "Dskip": _w(Dskip),
        }
    _A_in = _A_setup()

    def _B_setup():
        B, S, D = 1, 2048, 640
        return {
            "x": _w((lambda *s: torch.randn(*s, dtype=torch.bfloat16) * 0.2)(B, S, D)),
            "wqkv": _w((lambda *s: torch.randn(*s, dtype=torch.bfloat16) * 0.2)(D, 3 * D)),
            "wo": _w((lambda *s: torch.randn(*s, dtype=torch.bfloat16) * 0.05)(D, D)),
        }
    _B_in = _B_setup()

    return {
        "A_x": _A_in["x"],
        "A_Lambda_re": _A_in["Lambda_re"],
        "A_Lambda_im": _A_in["Lambda_im"],
        "A_B_re": _A_in["B_re"],
        "A_B_im": _A_in["B_im"],
        "A_C_re": _A_in["C_re"],
        "A_C_im": _A_in["C_im"],
        "A_log_dt": _A_in["log_dt"],
        "A_Dskip": _A_in["Dskip"],
        "B_x": _B_in["x"],
        "B_wqkv": _B_in["wqkv"],
        "B_wo": _B_in["wo"],
    }

def reference(A_x, A_Lambda_re, A_Lambda_im, A_B_re, A_B_im, A_C_re, A_C_im, A_log_dt, A_Dskip, B_x, B_wqkv, B_wo):
    def _A_ref(x, Lambda_re, Lambda_im, B_re, B_im, C_re, C_im, log_dt, Dskip):
        Bsz, L, H = x.shape
        Lam = Lambda_re + 1j * Lambda_im
        Bmat = B_re + 1j * B_im
        Cmat = C_re + 1j * C_im
        dt = torch.exp(log_dt)
        Lam_bar = torch.exp(dt * Lam)
        B_bar = ((Lam_bar - 1.0) / Lam)[:, None] * Bmat
        Bu = torch.einsum("bld,pd->blp", x + 0j, B_bar)
        h = torch.zeros_like(Bu[:, 0, :])
        hs = []
        for t in range(L):
            h = Lam_bar[None, :] * h + Bu[:, t, :]
            hs.append(h)
        hseq = torch.stack(hs, 1)
        y = 2.0 * torch.einsum("blp,dp->bld", hseq, Cmat).real + x * Dskip[None, None, :]
        return y

    def _B_ref(x, wqkv, wo):
        B, S, D = x.shape
        H = 32; Dh = D // H
        qkv = (lambda x, *d: x.permute(*d))((x @ wqkv).reshape(B, S, 3, H, Dh), 2, 0, 3, 1, 4)
        q, k, v = qkv[0], qkv[1], qkv[2]
        scale = Dh ** -0.5
        scores = torch.einsum("bhqd,bhkd->bhqk", q, k) * scale
        p = _softmax(scores, axis=-1)
        o = torch.einsum("bhqk,bhkd->bhqd", p, v)
        return (lambda x, *d: x.permute(*d))(o, 0, 2, 1, 3).reshape(B, S, D) @ wo

    a = _A_ref(A_x, A_Lambda_re, A_Lambda_im, A_B_re, A_B_im, A_C_re, A_C_im, A_log_dt, A_Dskip)
    b = _B_ref(B_x, B_wqkv, B_wo)
    return torch.concatenate([a, b], axis=-1)
```

```asm
; @launch grid=(512,1,1) block=(512,1,1) lds=81920
.amdgcn_target "amdgcn-amd-amdhsa--gfx950"
.text
.globl concat_heads__ssm_conv_s5__softmax_full_mha__prompt_kernel
.p2align 8
.type concat_heads__ssm_conv_s5__softmax_full_mha__prompt_kernel,@function
concat_heads__ssm_conv_s5__softmax_full_mha__prompt_kernel:
    s_load_dwordx4 s[88:91], s[0:1], 96
    s_load_dwordx2 s[4:5], s[0:1], 112
    s_cmp_ge_u32 s2, 512
    s_cbranch_scc1 m_exit
    v_lshrrev_b32 v1, 6, v0
    v_and_b32 v2, 63, v0
    v_readfirstlane_b32 s14, v1
    s_and_b32 s70, s2, 7
    s_bfe_u32 s71, s2, 0x50003
    s_and_b32 s15, s14, 3
    s_lshl_b32 s33, s15, 12
    s_and_b32 s28, s14, 1
    s_lshr_b32 s29, s15, 1
    s_cmp_ge_u32 s2, 256
    s_cbranch_scc1 m_s
    s_setprio 3
    s_mov_b32 s81, 0
    v_mov_b32 v16, 0
    s_and_b32 s30, s70, 1
    s_mul_i32 s31, s71, 43
    s_lshr_b32 s31, s31, 7
    s_mul_i32 s32, s31, 3
    s_sub_u32 s17, s71, s32
    s_mul_i32 s12, s30, 3
    s_add_u32 s12, s12, s17
    s_cmp_lt_u32 s71, 12
    s_cbranch_scc1 m_tm
    s_sub_u32 s32, s71, 12
    s_mul_i32 s31, s32, 52
    s_lshr_b32 s31, s31, 8
    s_mul_i32 s34, s31, 5
    s_sub_u32 s17, s32, s34
    s_mul_i32 s12, s30, 5
    s_add_u32 s12, s12, s17
    s_add_u32 s12, s12, 6
    s_add_u32 s17, s17, 3
m_tm:
    s_lshr_b32 s13, s70, 1
    s_lshl_b32 s13, s13, 2
    s_add_u32 s13, s13, s31
    s_mul_i32 s31, s31, 5
    s_add_u32 s31, s31, 1
    s_lshr_b32 s31, s31, 1
    s_add_u32 s17, s17, s31
    s_cmp_eq_u32 s13, 15
    s_cbranch_scc1 m_noq
    s_cmp_lt_u32 s14, 4
    s_cbranch_scc1 m_qc
    s_load_dwordx4 s[24:27], s[0:1], 72
    s_lshl_b32 s30, s12, 7
    s_lshl_b32 s31, s15, 5
    s_add_u32 s30, s30, s31
    s_mul_i32 s30, s30, 1280
    v_lshrrev_b32 v3, 3, v2
    v_mul_u32_u24 v3, 1280, v3
    v_add_u32 v3, s30, v3
    s_waitcnt lgkmcnt(0)
    v_lshrrev_b32 v12, 4, v2
    v_and_b32 v13, 7, v2
    v_xor_b32 v12, v12, v13
    v_xor_b32 v13, 4, v12
    v_lshl_add_u32 v4, v12, 4, v3
    v_lshl_add_u32 v5, v13, 4, v3
    v_add_u32 v5, 9216, v5
    v_add_u32 v6, 18432, v4
    v_add_u32 v7, 18432, v5
    s_lshl_b32 s31, s15, 4
    s_mul_i32 s31, s31, 3840
    s_lshl_b32 s32, s13, 8
    s_add_u32 s31, s31, s32
    v_lshrrev_b32 v12, 4, v2
    v_mul_u32_u24 v3, 3840, v12
    v_add_u32 v3, s31, v3
    v_and_b32 v13, 15, v2
    v_lshlrev_b32 v14, 2, v12
    v_xor_b32 v13, v13, v14
    v_lshl_add_u32 v8, v13, 4, v3
    v_add_u32 v9, 14336, v8
    v_add_u32 v10, 28672, v8
    v_add_u32 v11, 43008, v8
    s_mov_b32 s36, s24
    s_and_b32 s37, s25, 0xffff
    s_mov_b32 s38, 0x280000
    s_mov_b32 s39, 0x00020000
    s_mov_b32 s40, s26
    s_and_b32 s41, s27, 0xffff
    s_mov_b32 s42, 0x258000
    s_mov_b32 s43, 0x00020000
    s_add_u32 s6, s4, 12517376
    s_addc_u32 s7, s5, 0
    s_load_dword s80, s[6:7], 0
    s_mov_b32 s34, s17
    s_add_u32 s34, s34, s70
    s_cmp_ge_u32 s34, 10
    s_cselect_b32 s3, 10, 0
    s_sub_u32 s34, s34, s3
    s_cmp_ge_u32 s34, 10
    s_cselect_b32 s3, 10, 0
    s_sub_u32 s34, s34, s3
    s_mul_i32 s35, s34, 245760
    s_lshl_b32 s34, s34, 7
    s_add_u32 m0, s33, 0
    s_nop 0
    buffer_load_dwordx4 v4, s[36:39], s34 offen offset:0 lds
    buffer_load_dwordx4 v5, s[36:39], s34 offen offset:1024 lds
    buffer_load_dwordx4 v6, s[36:39], s34 offen offset:2048 lds
    buffer_load_dwordx4 v7, s[36:39], s34 offen offset:3072 lds
    s_add_u32 s34, s34, 128
    s_cmp_eq_u32 s34, 1280
    s_cselect_b32 s34, 0, s34
    s_add_u32 m0, s33, 16384
    s_nop 0
    buffer_load_dwordx4 v8, s[40:43], s35 offen offset:0 lds
    buffer_load_dwordx4 v9, s[40:43], s35 offen offset:1024 lds
    buffer_load_dwordx4 v10, s[40:43], s35 offen offset:2048 lds
    buffer_load_dwordx4 v11, s[40:43], s35 offen offset:3072 lds
    s_add_u32 s35, s35, 245760
    s_cmp_eq_u32 s35, 2457600
    s_cselect_b32 s35, 0, s35
    s_add_u32 m0, s33, 32768
    s_nop 0
    buffer_load_dwordx4 v4, s[36:39], s34 offen offset:0 lds
    buffer_load_dwordx4 v5, s[36:39], s34 offen offset:1024 lds
    buffer_load_dwordx4 v6, s[36:39], s34 offen offset:2048 lds
    buffer_load_dwordx4 v7, s[36:39], s34 offen offset:3072 lds
    s_add_u32 s34, s34, 128
    s_cmp_eq_u32 s34, 1280
    s_cselect_b32 s34, 0, s34
    s_add_u32 m0, s33, 49152
    s_nop 0
    buffer_load_dwordx4 v8, s[40:43], s35 offen offset:0 lds
    buffer_load_dwordx4 v9, s[40:43], s35 offen offset:1024 lds
    buffer_load_dwordx4 v10, s[40:43], s35 offen offset:2048 lds
    buffer_load_dwordx4 v11, s[40:43], s35 offen offset:3072 lds
    s_add_u32 s35, s35, 245760
    s_cmp_eq_u32 s35, 2457600
    s_cselect_b32 s35, 0, s35
    s_waitcnt lgkmcnt(0)
    s_add_u32 s80, s80, 1
    s_waitcnt vmcnt(8)
    s_barrier
    s_add_u32 m0, s33, 65536
    s_nop 0
    buffer_load_dwordx4 v4, s[36:39], s34 offen offset:0 lds
    buffer_load_dwordx4 v5, s[36:39], s34 offen offset:1024 lds
    buffer_load_dwordx4 v6, s[36:39], s34 offen offset:2048 lds
    buffer_load_dwordx4 v7, s[36:39], s34 offen offset:3072 lds
    s_add_u32 s34, s34, 128
    s_cmp_eq_u32 s34, 1280
    s_cselect_b32 s34, 0, s34
    s_waitcnt vmcnt(4)
    s_barrier
    s_add_u32 m0, s33, 0
    s_nop 0
    buffer_load_dwordx4 v8, s[40:43], s35 offen offset:0 lds
    buffer_load_dwordx4 v9, s[40:43], s35 offen offset:1024 lds
    buffer_load_dwordx4 v10, s[40:43], s35 offen offset:2048 lds
    buffer_load_dwordx4 v11, s[40:43], s35 offen offset:3072 lds
    s_add_u32 s35, s35, 245760
    s_cmp_eq_u32 s35, 2457600
    s_cselect_b32 s35, 0, s35
    s_add_u32 m0, s33, 16384
    s_nop 0
    buffer_load_dwordx4 v4, s[36:39], s34 offen offset:0 lds
    buffer_load_dwordx4 v5, s[36:39], s34 offen offset:1024 lds
    buffer_load_dwordx4 v6, s[36:39], s34 offen offset:2048 lds
    buffer_load_dwordx4 v7, s[36:39], s34 offen offset:3072 lds
    s_add_u32 s34, s34, 128
    s_cmp_eq_u32 s34, 1280
    s_cselect_b32 s34, 0, s34
    s_waitcnt vmcnt(4)
    s_barrier
    s_add_u32 m0, s33, 32768
    s_nop 0
    buffer_load_dwordx4 v8, s[40:43], s35 offen offset:0 lds
    buffer_load_dwordx4 v9, s[40:43], s35 offen offset:1024 lds
    buffer_load_dwordx4 v10, s[40:43], s35 offen offset:2048 lds
    buffer_load_dwordx4 v11, s[40:43], s35 offen offset:3072 lds
    s_add_u32 s35, s35, 245760
    s_cmp_eq_u32 s35, 2457600
    s_cselect_b32 s35, 0, s35
    s_add_u32 m0, s33, 49152
    s_nop 0
    buffer_load_dwordx4 v4, s[36:39], s34 offen offset:0 lds
    buffer_load_dwordx4 v5, s[36:39], s34 offen offset:1024 lds
    buffer_load_dwordx4 v6, s[36:39], s34 offen offset:2048 lds
    buffer_load_dwordx4 v7, s[36:39], s34 offen offset:3072 lds
    s_add_u32 s34, s34, 128
    s_cmp_eq_u32 s34, 1280
    s_cselect_b32 s34, 0, s34
    s_waitcnt vmcnt(4)
    s_barrier
    s_add_u32 m0, s33, 65536
    s_nop 0
    buffer_load_dwordx4 v8, s[40:43], s35 offen offset:0 lds
    buffer_load_dwordx4 v9, s[40:43], s35 offen offset:1024 lds
    buffer_load_dwordx4 v10, s[40:43], s35 offen offset:2048 lds
    buffer_load_dwordx4 v11, s[40:43], s35 offen offset:3072 lds
    s_add_u32 s35, s35, 245760
    s_cmp_eq_u32 s35, 2457600
    s_cselect_b32 s35, 0, s35
    s_add_u32 m0, s33, 0
    s_nop 0
    buffer_load_dwordx4 v4, s[36:39], s34 offen offset:0 lds
    buffer_load_dwordx4 v5, s[36:39], s34 offen offset:1024 lds
    buffer_load_dwordx4 v6, s[36:39], s34 offen offset:2048 lds
    buffer_load_dwordx4 v7, s[36:39], s34 offen offset:3072 lds
    s_add_u32 s34, s34, 128
    s_cmp_eq_u32 s34, 1280
    s_cselect_b32 s34, 0, s34
    s_waitcnt vmcnt(4)
    s_barrier
    s_add_u32 m0, s33, 16384
    s_nop 0
    buffer_load_dwordx4 v8, s[40:43], s35 offen offset:0 lds
    buffer_load_dwordx4 v9, s[40:43], s35 offen offset:1024 lds
    buffer_load_dwordx4 v10, s[40:43], s35 offen offset:2048 lds
    buffer_load_dwordx4 v11, s[40:43], s35 offen offset:3072 lds
    s_add_u32 s35, s35, 245760
    s_cmp_eq_u32 s35, 2457600
    s_cselect_b32 s35, 0, s35
    s_add_u32 m0, s33, 32768
    s_nop 0
    buffer_load_dwordx4 v4, s[36:39], s34 offen offset:0 lds
    buffer_load_dwordx4 v5, s[36:39], s34 offen offset:1024 lds
    buffer_load_dwordx4 v6, s[36:39], s34 offen offset:2048 lds
    buffer_load_dwordx4 v7, s[36:39], s34 offen offset:3072 lds
    s_add_u32 s34, s34, 128
    s_cmp_eq_u32 s34, 1280
    s_cselect_b32 s34, 0, s34
    s_waitcnt vmcnt(4)
    s_barrier
    s_add_u32 m0, s33, 49152
    s_nop 0
    buffer_load_dwordx4 v8, s[40:43], s35 offen offset:0 lds
    buffer_load_dwordx4 v9, s[40:43], s35 offen offset:1024 lds
    buffer_load_dwordx4 v10, s[40:43], s35 offen offset:2048 lds
    buffer_load_dwordx4 v11, s[40:43], s35 offen offset:3072 lds
    s_add_u32 s35, s35, 245760
    s_cmp_eq_u32 s35, 2457600
    s_cselect_b32 s35, 0, s35
    s_add_u32 m0, s33, 65536
    s_nop 0
    buffer_load_dwordx4 v4, s[36:39], s34 offen offset:0 lds
    buffer_load_dwordx4 v5, s[36:39], s34 offen offset:1024 lds
    buffer_load_dwordx4 v6, s[36:39], s34 offen offset:2048 lds
    buffer_load_dwordx4 v7, s[36:39], s34 offen offset:3072 lds
    s_add_u32 s34, s34, 128
    s_cmp_eq_u32 s34, 1280
    s_cselect_b32 s34, 0, s34
    s_waitcnt vmcnt(4)
    s_barrier
    s_add_u32 m0, s33, 0
    s_nop 0
    buffer_load_dwordx4 v8, s[40:43], s35 offen offset:0 lds
    buffer_load_dwordx4 v9, s[40:43], s35 offen offset:1024 lds
    buffer_load_dwordx4 v10, s[40:43], s35 offen offset:2048 lds
    buffer_load_dwordx4 v11, s[40:43], s35 offen offset:3072 lds
    s_add_u32 s35, s35, 245760
    s_cmp_eq_u32 s35, 2457600
    s_cselect_b32 s35, 0, s35
    s_add_u32 m0, s33, 16384
    s_nop 0
    buffer_load_dwordx4 v4, s[36:39], s34 offen offset:0 lds
    buffer_load_dwordx4 v5, s[36:39], s34 offen offset:1024 lds
    buffer_load_dwordx4 v6, s[36:39], s34 offen offset:2048 lds
    buffer_load_dwordx4 v7, s[36:39], s34 offen offset:3072 lds
    s_add_u32 s34, s34, 128
    s_cmp_eq_u32 s34, 1280
    s_cselect_b32 s34, 0, s34
    s_waitcnt vmcnt(4)
    s_barrier
    s_add_u32 m0, s33, 32768
    s_nop 0
    buffer_load_dwordx4 v8, s[40:43], s35 offen offset:0 lds
    buffer_load_dwordx4 v9, s[40:43], s35 offen offset:1024 lds
    buffer_load_dwordx4 v10, s[40:43], s35 offen offset:2048 lds
    buffer_load_dwordx4 v11, s[40:43], s35 offen offset:3072 lds
    s_add_u32 s35, s35, 245760
    s_cmp_eq_u32 s35, 2457600
    s_cselect_b32 s35, 0, s35
    s_add_u32 m0, s33, 49152
    s_nop 0
    buffer_load_dwordx4 v4, s[36:39], s34 offen offset:0 lds
    buffer_load_dwordx4 v5, s[36:39], s34 offen offset:1024 lds
    buffer_load_dwordx4 v6, s[36:39], s34 offen offset:2048 lds
    buffer_load_dwordx4 v7, s[36:39], s34 offen offset:3072 lds
    s_add_u32 s34, s34, 128
    s_cmp_eq_u32 s34, 1280
    s_cselect_b32 s34, 0, s34
    s_waitcnt vmcnt(4)
    s_barrier
    s_add_u32 m0, s33, 65536
    s_nop 0
    buffer_load_dwordx4 v8, s[40:43], s35 offen offset:0 lds
    buffer_load_dwordx4 v9, s[40:43], s35 offen offset:1024 lds
    buffer_load_dwordx4 v10, s[40:43], s35 offen offset:2048 lds
    buffer_load_dwordx4 v11, s[40:43], s35 offen offset:3072 lds
    s_add_u32 s35, s35, 245760
    s_cmp_eq_u32 s35, 2457600
    s_cselect_b32 s35, 0, s35
    s_waitcnt vmcnt(0)
    s_barrier
    s_barrier
    s_mov_b32 s8, s4
    s_and_b32 s9, s5, 0xffff
    s_mov_b32 s10, 0x1600000
    s_mov_b32 s11, 0x00020000
    s_mov_b32 s92, s88
    s_and_b32 s93, s89, 0xffff
    s_mov_b32 s94, 0xa00000
    s_mov_b32 s95, 0x00020000
    s_mov_b32 s84, s90
    s_and_b32 s85, s91, 0xffff
    s_mov_b32 s86, 0x100
    s_mov_b32 s87, 0x00020000
    s_branch m_att
m_qc:
    s_waitcnt lgkmcnt(0)
    s_add_u32 s6, s4, 12517376
    s_addc_u32 s7, s5, 0
    s_load_dword s80, s[6:7], 0
    s_mov_b32 s8, s4
    s_and_b32 s9, s5, 0xffff
    s_mov_b32 s10, 0x1600000
    s_mov_b32 s11, 0x00020000
    s_mov_b32 s92, s88
    s_and_b32 s93, s89, 0xffff
    s_mov_b32 s94, 0xa00000
    s_mov_b32 s95, 0x00020000
    s_mov_b32 s84, s90
    s_and_b32 s85, s91, 0xffff
    s_mov_b32 s86, 0x100
    s_mov_b32 s87, 0x00020000
    v_and_b32 v28, 31, v2
    v_lshrrev_b32 v29, 5, v2
    v_bfe_u32 v30, v2, 1, 3
    v_xor_b32 v29, v29, v30
    v_lshlrev_b32 v29, 4, v29
    v_lshl_add_u32 v28, v28, 7, v29
    s_mul_i32 s30, s28, 8192
    v_add_u32 v4, s30, v28
    v_xor_b32 v5, 32, v4
    v_xor_b32 v6, 64, v4
    v_xor_b32 v7, 96, v4
    v_bfe_u32 v28, v2, 4, 1
    v_and_b32 v29, 1, v2
    v_lshl_add_u32 v28, v28, 1, v29
    v_bfe_u32 v29, v2, 2, 2
    v_lshrrev_b32 v30, 5, v2
    v_lshl_add_u32 v30, v30, 3, v29
    v_mul_u32_u24 v30, 256, v30
    v_lshl_add_u32 v30, v28, 4, v30
    v_bfe_u32 v28, v2, 1, 1
    v_lshl_add_u32 v30, v28, 3, v30
    s_lshl_b32 s30, s29, 1
    v_xor_b32 v28, s30, v29
    v_xor_b32 v31, 1, v28
    v_lshl_add_u32 v8, v28, 6, v30
    v_lshl_add_u32 v9, v31, 6, v30
    v_add_u32 v10, 49152, v4
    v_add_u32 v11, 49152, v5
    v_add_u32 v12, 49152, v6
    v_add_u32 v13, 49152, v7
    v_add_u32 v14, 49152, v8
    v_add_u32 v15, 49152, v9
    v_mov_b32 v60, 0
    v_mov_b32 v61, 0
    v_mov_b32 v62, 0
    v_mov_b32 v63, 0
    v_mov_b32 v64, 0
    v_mov_b32 v65, 0
    v_mov_b32 v66, 0
    v_mov_b32 v67, 0
    v_mov_b32 v68, 0
    v_mov_b32 v69, 0
    v_mov_b32 v70, 0
    v_mov_b32 v71, 0
    v_mov_b32 v72, 0
    v_mov_b32 v73, 0
    v_mov_b32 v74, 0
    v_mov_b32 v75, 0
    v_mov_b32 v76, 0
    v_mov_b32 v77, 0
    v_mov_b32 v78, 0
    v_mov_b32 v79, 0
    v_mov_b32 v80, 0
    v_mov_b32 v81, 0
    v_mov_b32 v82, 0
    v_mov_b32 v83, 0
    v_mov_b32 v84, 0
    v_mov_b32 v85, 0
    v_mov_b32 v86, 0
    v_mov_b32 v87, 0
    v_mov_b32 v88, 0
    v_mov_b32 v89, 0
    v_mov_b32 v90, 0
    v_mov_b32 v91, 0
    v_mov_b32 v92, 0
    v_mov_b32 v93, 0
    v_mov_b32 v94, 0
    v_mov_b32 v95, 0
    v_mov_b32 v96, 0
    v_mov_b32 v97, 0
    v_mov_b32 v98, 0
    v_mov_b32 v99, 0
    v_mov_b32 v100, 0
    v_mov_b32 v101, 0
    v_mov_b32 v102, 0
    v_mov_b32 v103, 0
    v_mov_b32 v104, 0
    v_mov_b32 v105, 0
    v_mov_b32 v106, 0
    v_mov_b32 v107, 0
    v_mov_b32 v108, 0
    v_mov_b32 v109, 0
    v_mov_b32 v110, 0
    v_mov_b32 v111, 0
    v_mov_b32 v112, 0
    v_mov_b32 v113, 0
    v_mov_b32 v114, 0
    v_mov_b32 v115, 0
    v_mov_b32 v116, 0
    v_mov_b32 v117, 0
    v_mov_b32 v118, 0
    v_mov_b32 v119, 0
    v_mov_b32 v120, 0
    v_mov_b32 v121, 0
    v_mov_b32 v122, 0
    v_mov_b32 v123, 0
    v_and_b32 v126, 31, v2
    v_lshrrev_b32 v127, 5, v2
    s_cmp_ge_u32 s13, 5
    s_cselect_b32 s30, 1, 0
    s_cmp_ge_u32 s13, 10
    s_addc_u32 s30, s30, 0
    s_mul_i32 s31, s30, 5
    s_sub_u32 s31, s13, s31
    s_lshl_b32 s31, s31, 1
    s_add_u32 s31, s31, s29
    s_lshl_b32 s32, s31, 6
    s_mul_i32 s33, s32, 3277
    s_lshr_b32 s33, s33, 16
    s_add_u32 s32, s32, 63
    s_mul_i32 s32, s32, 3277
    s_lshr_b32 s32, s32, 16
    v_add_u32 v28, s33, v2
    v_mul_u32_u24 v29, 20, v28
    v_lshrrev_b32 v29, 6, v29
    v_sub_u32 v29, s31, v29
    v_mul_u32_u24 v30, 4864, v28
    v_lshl_add_u32 v30, v29, 7, v30
    s_lshl_b32 s30, s30, 8
    s_lshl_b32 s34, s12, 3
    s_add_u32 s30, s30, s34
    s_lshl_b32 s34, s28, 2
    s_add_u32 s30, s30, s34
    s_add_u32 s30, s30, 11534336
    v_add_u32 v16, s30, v30
    v_cmp_ge_u32 s[74:75], s32, v28
    s_waitcnt lgkmcnt(0)
    s_add_u32 s80, s80, 1
    v_mov_b32 v17, s80
    s_cmp_ge_u32 s13, 10
    s_cbranch_scc1 q_consV
    s_lshl_b32 s30, s13, 4
    s_lshl_b32 s31, s29, 3
    s_add_u32 s30, s30, s31
    s_lshl_b32 s30, s30, 15
    s_lshl_b32 s31, s12, 11
    s_add_u32 s30, s30, s31
    s_lshl_b32 s31, s28, 10
    s_add_u32 s30, s30, s31
    v_lshlrev_b32 v124, 15, v127
    v_lshl_add_u32 v124, v126, 4, v124
    v_add_u32 v124, s30, v124
    s_barrier
    ds_read_b64_tr_b16 v[36:37], v8 offset:16384
    ds_read_b64_tr_b16 v[38:39], v8 offset:17408
    ds_read_b128 v[28:31], v4 offset:0
    ds_read_b128 v[32:35], v4 offset:4096
    ds_read_b64_tr_b16 v[40:41], v9 offset:16384
    ds_read_b64_tr_b16 v[42:43], v9 offset:17408
    ds_read_b64_tr_b16 v[52:53], v8 offset:20480
    ds_read_b64_tr_b16 v[54:55], v8 offset:21504
    ds_read_b128 v[44:47], v5 offset:0
    ds_read_b128 v[48:51], v5 offset:4096
    ds_read_b64_tr_b16 v[56:57], v9 offset:20480
    ds_read_b64_tr_b16 v[58:59], v9 offset:21504
    s_waitcnt lgkmcnt(0)
    s_mov_b32 s34, 0
.p2align 3
q_lqk:
    s_waitcnt lgkmcnt(9)
    v_mfma_f32_32x32x16_bf16 v[60:75], v[36:39], v[28:31], v[60:75]
    s_waitcnt lgkmcnt(8)
    v_mfma_f32_32x32x16_bf16 v[76:91], v[36:39], v[32:35], v[76:91]
    ds_read_b64_tr_b16 v[36:37], v8 offset:24576
    ds_read_b64_tr_b16 v[38:39], v8 offset:25600
    s_waitcnt lgkmcnt(8)
    v_mfma_f32_32x32x16_bf16 v[92:107], v[40:43], v[28:31], v[92:107]
    ds_read_b128 v[28:31], v6 offset:0
    v_mfma_f32_32x32x16_bf16 v[108:123], v[40:43], v[32:35], v[108:123]
    ds_read_b128 v[32:35], v6 offset:4096
    ds_read_b64_tr_b16 v[40:41], v9 offset:24576
    ds_read_b64_tr_b16 v[42:43], v9 offset:25600
    s_waitcnt lgkmcnt(9)
    v_mfma_f32_32x32x16_bf16 v[60:75], v[52:55], v[44:47], v[60:75]
    s_waitcnt lgkmcnt(8)
    v_mfma_f32_32x32x16_bf16 v[76:91], v[52:55], v[48:51], v[76:91]
    ds_read_b64_tr_b16 v[52:53], v8 offset:28672
    ds_read_b64_tr_b16 v[54:55], v8 offset:29696
    s_waitcnt lgkmcnt(8)
    v_mfma_f32_32x32x16_bf16 v[92:107], v[56:59], v[44:47], v[92:107]
    ds_read_b128 v[44:47], v7 offset:0
    v_mfma_f32_32x32x16_bf16 v[108:123], v[56:59], v[48:51], v[108:123]
    ds_read_b128 v[48:51], v7 offset:4096
    ds_read_b64_tr_b16 v[56:57], v9 offset:28672
    ds_read_b64_tr_b16 v[58:59], v9 offset:29696
    s_waitcnt lgkmcnt(9)
    v_mfma_f32_32x32x16_bf16 v[60:75], v[36:39], v[28:31], v[60:75]
    s_waitcnt lgkmcnt(8)
    v_mfma_f32_32x32x16_bf16 v[76:91], v[36:39], v[32:35], v[76:91]
    s_waitcnt lgkmcnt(0)
    s_barrier
    ds_read_b64_tr_b16 v[36:37], v14 offset:0
    ds_read_b64_tr_b16 v[38:39], v14 offset:1024
    v_mfma_f32_32x32x16_bf16 v[92:107], v[40:43], v[28:31], v[92:107]
    ds_read_b128 v[28:31], v4 offset:32768
    v_mfma_f32_32x32x16_bf16 v[108:123], v[40:43], v[32:35], v[108:123]
    ds_read_b128 v[32:35], v4 offset:36864
    ds_read_b64_tr_b16 v[40:41], v15 offset:0
    ds_read_b64_tr_b16 v[42:43], v15 offset:1024
    v_mfma_f32_32x32x16_bf16 v[60:75], v[52:55], v[44:47], v[60:75]
    v_mfma_f32_32x32x16_bf16 v[76:91], v[52:55], v[48:51], v[76:91]
    ds_read_b64_tr_b16 v[52:53], v14 offset:4096
    ds_read_b64_tr_b16 v[54:55], v14 offset:5120
    v_mfma_f32_32x32x16_bf16 v[92:107], v[56:59], v[44:47], v[92:107]
    ds_read_b128 v[44:47], v5 offset:32768
    v_mfma_f32_32x32x16_bf16 v[108:123], v[56:59], v[48:51], v[108:123]
    ds_read_b128 v[48:51], v5 offset:36864
    ds_read_b64_tr_b16 v[56:57], v15 offset:4096
    ds_read_b64_tr_b16 v[58:59], v15 offset:5120
    s_waitcnt lgkmcnt(9)
    v_mfma_f32_32x32x16_bf16 v[60:75], v[36:39], v[28:31], v[60:75]
    s_waitcnt lgkmcnt(8)
    v_mfma_f32_32x32x16_bf16 v[76:91], v[36:39], v[32:35], v[76:91]
    ds_read_b64_tr_b16 v[36:37], v14 offset:8192
    ds_read_b64_tr_b16 v[38:39], v14 offset:9216
    s_waitcnt lgkmcnt(8)
    v_mfma_f32_32x32x16_bf16 v[92:107], v[40:43], v[28:31], v[92:107]
    ds_read_b128 v[28:31], v6 offset:32768
    v_mfma_f32_32x32x16_bf16 v[108:123], v[40:43], v[32:35], v[108:123]
    ds_read_b128 v[32:35], v6 offset:36864
    ds_read_b64_tr_b16 v[40:41], v15 offset:8192
    ds_read_b64_tr_b16 v[42:43], v15 offset:9216
    s_waitcnt lgkmcnt(9)
    v_mfma_f32_32x32x16_bf16 v[60:75], v[52:55], v[44:47], v[60:75]
    s_waitcnt lgkmcnt(8)
    v_mfma_f32_32x32x16_bf16 v[76:91], v[52:55], v[48:51], v[76:91]
    ds_read_b64_tr_b16 v[52:53], v14 offset:12288
    ds_read_b64_tr_b16 v[54:55], v14 offset:13312
    s_waitcnt lgkmcnt(8)
    v_mfma_f32_32x32x16_bf16 v[92:107], v[56:59], v[44:47], v[92:107]
    ds_read_b128 v[44:47], v7 offset:32768
    v_mfma_f32_32x32x16_bf16 v[108:123], v[56:59], v[48:51], v[108:123]
    ds_read_b128 v[48:51], v7 offset:36864
    ds_read_b64_tr_b16 v[56:57], v15 offset:12288
    ds_read_b64_tr_b16 v[58:59], v15 offset:13312
    s_waitcnt lgkmcnt(9)
    v_mfma_f32_32x32x16_bf16 v[60:75], v[36:39], v[28:31], v[60:75]
    s_waitcnt lgkmcnt(8)
    v_mfma_f32_32x32x16_bf16 v[76:91], v[36:39], v[32:35], v[76:91]
    s_waitcnt lgkmcnt(0)
    s_barrier
    ds_read_b64_tr_b16 v[36:37], v8 offset:0
    ds_read_b64_tr_b16 v[38:39], v8 offset:1024
    v_mfma_f32_32x32x16_bf16 v[92:107], v[40:43], v[28:31], v[92:107]
    ds_read_b128 v[28:31], v10 offset:16384
    v_mfma_f32_32x32x16_bf16 v[108:123], v[40:43], v[32:35], v[108:123]
    ds_read_b128 v[32:35], v10 offset:20480
    ds_read_b64_tr_b16 v[40:41], v9 offset:0
    ds_read_b64_tr_b16 v[42:43], v9 offset:1024
    v_mfma_f32_32x32x16_bf16 v[60:75], v[52:55], v[44:47], v[60:75]
    v_mfma_f32_32x32x16_bf16 v[76:91], v[52:55], v[48:51], v[76:91]
    ds_read_b64_tr_b16 v[52:53], v8 offset:4096
    ds_read_b64_tr_b16 v[54:55], v8 offset:5120
    v_mfma_f32_32x32x16_bf16 v[92:107], v[56:59], v[44:47], v[92:107]
    ds_read_b128 v[44:47], v11 offset:16384
    v_mfma_f32_32x32x16_bf16 v[108:123], v[56:59], v[48:51], v[108:123]
    ds_read_b128 v[48:51], v11 offset:20480
    ds_read_b64_tr_b16 v[56:57], v9 offset:4096
    ds_read_b64_tr_b16 v[58:59], v9 offset:5120
    s_waitcnt lgkmcnt(9)
    v_mfma_f32_32x32x16_bf16 v[60:75], v[36:39], v[28:31], v[60:75]
    s_waitcnt lgkmcnt(8)
    v_mfma_f32_32x32x16_bf16 v[76:91], v[36:39], v[32:35], v[76:91]
    ds_read_b64_tr_b16 v[36:37], v8 offset:8192
    ds_read_b64_tr_b16 v[38:39], v8 offset:9216
    s_waitcnt lgkmcnt(8)
    v_mfma_f32_32x32x16_bf16 v[92:107], v[40:43], v[28:31], v[92:107]
    ds_read_b128 v[28:31], v12 offset:16384
    v_mfma_f32_32x32x16_bf16 v[108:123], v[40:43], v[32:35], v[108:123]
    ds_read_b128 v[32:35], v12 offset:20480
    ds_read_b64_tr_b16 v[40:41], v9 offset:8192
    ds_read_b64_tr_b16 v[42:43], v9 offset:9216
    s_waitcnt lgkmcnt(9)
    v_mfma_f32_32x32x16_bf16 v[60:75], v[52:55], v[44:47], v[60:75]
    s_waitcnt lgkmcnt(8)
    v_mfma_f32_32x32x16_bf16 v[76:91], v[52:55], v[48:51], v[76:91]
    ds_read_b64_tr_b16 v[52:53], v8 offset:12288
    ds_read_b64_tr_b16 v[54:55], v8 offset:13312
    s_waitcnt lgkmcnt(8)
    v_mfma_f32_32x32x16_bf16 v[92:107], v[56:59], v[44:47], v[92:107]
    ds_read_b128 v[44:47], v13 offset:16384
    v_mfma_f32_32x32x16_bf16 v[108:123], v[56:59], v[48:51], v[108:123]
    ds_read_b128 v[48:51], v13 offset:20480
    ds_read_b64_tr_b16 v[56:57], v9 offset:12288
    ds_read_b64_tr_b16 v[58:59], v9 offset:13312
    s_waitcnt lgkmcnt(9)
    v_mfma_f32_32x32x16_bf16 v[60:75], v[36:39], v[28:31], v[60:75]
    s_waitcnt lgkmcnt(8)
    v_mfma_f32_32x32x16_bf16 v[76:91], v[36:39], v[32:35], v[76:91]
    s_waitcnt lgkmcnt(0)
    s_barrier
    ds_read_b64_tr_b16 v[36:37], v8 offset:32768
    ds_read_b64_tr_b16 v[38:39], v8 offset:33792
    v_mfma_f32_32x32x16_bf16 v[92:107], v[40:43], v[28:31], v[92:107]
    ds_read_b128 v[28:31], v4 offset:16384
    v_mfma_f32_32x32x16_bf16 v[108:123], v[40:43], v[32:35], v[108:123]
    ds_read_b128 v[32:35], v4 offset:20480
    ds_read_b64_tr_b16 v[40:41], v9 offset:32768
    ds_read_b64_tr_b16 v[42:43], v9 offset:33792
    v_mfma_f32_32x32x16_bf16 v[60:75], v[52:55], v[44:47], v[60:75]
    v_mfma_f32_32x32x16_bf16 v[76:91], v[52:55], v[48:51], v[76:91]
    ds_read_b64_tr_b16 v[52:53], v8 offset:36864
    ds_read_b64_tr_b16 v[54:55], v8 offset:37888
    v_mfma_f32_32x32x16_bf16 v[92:107], v[56:59], v[44:47], v[92:107]
    ds_read_b128 v[44:47], v5 offset:16384
    v_mfma_f32_32x32x16_bf16 v[108:123], v[56:59], v[48:51], v[108:123]
    ds_read_b128 v[48:51], v5 offset:20480
    ds_read_b64_tr_b16 v[56:57], v9 offset:36864
    ds_read_b64_tr_b16 v[58:59], v9 offset:37888
    s_waitcnt lgkmcnt(9)
    v_mfma_f32_32x32x16_bf16 v[60:75], v[36:39], v[28:31], v[60:75]
    s_waitcnt lgkmcnt(8)
    v_mfma_f32_32x32x16_bf16 v[76:91], v[36:39], v[32:35], v[76:91]
    ds_read_b64_tr_b16 v[36:37], v8 offset:40960
    ds_read_b64_tr_b16 v[38:39], v8 offset:41984
    s_waitcnt lgkmcnt(8)
    v_mfma_f32_32x32x16_bf16 v[92:107], v[40:43], v[28:31], v[92:107]
    ds_read_b128 v[28:31], v6 offset:16384
    v_mfma_f32_32x32x16_bf16 v[108:123], v[40:43], v[32:35], v[108:123]
    ds_read_b128 v[32:35], v6 offset:20480
    ds_read_b64_tr_b16 v[40:41], v9 offset:40960
    ds_read_b64_tr_b16 v[42:43], v9 offset:41984
    s_waitcnt lgkmcnt(9)
    v_mfma_f32_32x32x16_bf16 v[60:75], v[52:55], v[44:47], v[60:75]
    s_waitcnt lgkmcnt(8)
    v_mfma_f32_32x32x16_bf16 v[76:91], v[52:55], v[48:51], v[76:91]
    ds_read_b64_tr_b16 v[52:53], v8 offset:45056
    ds_read_b64_tr_b16 v[54:55], v8 offset:46080
    s_waitcnt lgkmcnt(8)
    v_mfma_f32_32x32x16_bf16 v[92:107], v[56:59], v[44:47], v[92:107]
    ds_read_b128 v[44:47], v7 offset:16384
    v_mfma_f32_32x32x16_bf16 v[108:123], v[56:59], v[48:51], v[108:123]
    ds_read_b128 v[48:51], v7 offset:20480
    ds_read_b64_tr_b16 v[56:57], v9 offset:45056
    ds_read_b64_tr_b16 v[58:59], v9 offset:46080
    s_waitcnt lgkmcnt(9)
    v_mfma_f32_32x32x16_bf16 v[60:75], v[36:39], v[28:31], v[60:75]
    s_waitcnt lgkmcnt(8)
    v_mfma_f32_32x32x16_bf16 v[76:91], v[36:39], v[32:35], v[76:91]
    s_waitcnt lgkmcnt(0)
    s_barrier
    ds_read_b64_tr_b16 v[36:37], v14 offset:16384
    ds_read_b64_tr_b16 v[38:39], v14 offset:17408
    v_mfma_f32_32x32x16_bf16 v[92:107], v[40:43], v[28:31], v[92:107]
    ds_read_b128 v[28:31], v10 offset:0
    v_mfma_f32_32x32x16_bf16 v[108:123], v[40:43], v[32:35], v[108:123]
    ds_read_b128 v[32:35], v10 offset:4096
    ds_read_b64_tr_b16 v[40:41], v15 offset:16384
    ds_read_b64_tr_b16 v[42:43], v15 offset:17408
    v_mfma_f32_32x32x16_bf16 v[60:75], v[52:55], v[44:47], v[60:75]
    v_mfma_f32_32x32x16_bf16 v[76:91], v[52:55], v[48:51], v[76:91]
    ds_read_b64_tr_b16 v[52:53], v14 offset:20480
    ds_read_b64_tr_b16 v[54:55], v14 offset:21504
    v_mfma_f32_32x32x16_bf16 v[92:107], v[56:59], v[44:47], v[92:107]
    ds_read_b128 v[44:47], v11 offset:0
    v_mfma_f32_32x32x16_bf16 v[108:123], v[56:59], v[48:51], v[108:123]
    ds_read_b128 v[48:51], v11 offset:4096
    ds_read_b64_tr_b16 v[56:57], v15 offset:20480
    ds_read_b64_tr_b16 v[58:59], v15 offset:21504
    s_waitcnt lgkmcnt(9)
    v_mfma_f32_32x32x16_bf16 v[60:75], v[36:39], v[28:31], v[60:75]
    s_waitcnt lgkmcnt(8)
    v_mfma_f32_32x32x16_bf16 v[76:91], v[36:39], v[32:35], v[76:91]
    ds_read_b64_tr_b16 v[36:37], v14 offset:24576
    ds_read_b64_tr_b16 v[38:39], v14 offset:25600
    s_waitcnt lgkmcnt(8)
    v_mfma_f32_32x32x16_bf16 v[92:107], v[40:43], v[28:31], v[92:107]
    ds_read_b128 v[28:31], v12 offset:0
    v_mfma_f32_32x32x16_bf16 v[108:123], v[40:43], v[32:35], v[108:123]
    ds_read_b128 v[32:35], v12 offset:4096
    ds_read_b64_tr_b16 v[40:41], v15 offset:24576
    ds_read_b64_tr_b16 v[42:43], v15 offset:25600
    s_waitcnt lgkmcnt(9)
    v_mfma_f32_32x32x16_bf16 v[60:75], v[52:55], v[44:47], v[60:75]
    s_waitcnt lgkmcnt(8)
    v_mfma_f32_32x32x16_bf16 v[76:91], v[52:55], v[48:51], v[76:91]
    ds_read_b64_tr_b16 v[52:53], v14 offset:28672
    ds_read_b64_tr_b16 v[54:55], v14 offset:29696
    s_waitcnt lgkmcnt(8)
    v_mfma_f32_32x32x16_bf16 v[92:107], v[56:59], v[44:47], v[92:107]
    ds_read_b128 v[44:47], v13 offset:0
    v_mfma_f32_32x32x16_bf16 v[108:123], v[56:59], v[48:51], v[108:123]
    ds_read_b128 v[48:51], v13 offset:4096
    ds_read_b64_tr_b16 v[56:57], v15 offset:28672
    ds_read_b64_tr_b16 v[58:59], v15 offset:29696
    s_waitcnt lgkmcnt(9)
    v_mfma_f32_32x32x16_bf16 v[60:75], v[36:39], v[28:31], v[60:75]
    s_waitcnt lgkmcnt(8)
    v_mfma_f32_32x32x16_bf16 v[76:91], v[36:39], v[32:35], v[76:91]
    s_waitcnt lgkmcnt(0)
    s_barrier
    ds_read_b64_tr_b16 v[36:37], v8 offset:16384
    ds_read_b64_tr_b16 v[38:39], v8 offset:17408
    v_mfma_f32_32x32x16_bf16 v[92:107], v[40:43], v[28:31], v[92:107]
    ds_read_b128 v[28:31], v4 offset:0
    v_mfma_f32_32x32x16_bf16 v[108:123], v[40:43], v[32:35], v[108:123]
    ds_read_b128 v[32:35], v4 offset:4096
    ds_read_b64_tr_b16 v[40:41], v9 offset:16384
    ds_read_b64_tr_b16 v[42:43], v9 offset:17408
    v_mfma_f32_32x32x16_bf16 v[60:75], v[52:55], v[44:47], v[60:75]
    v_mfma_f32_32x32x16_bf16 v[76:91], v[52:55], v[48:51], v[76:91]
    ds_read_b64_tr_b16 v[52:53], v8 offset:20480
    ds_read_b64_tr_b16 v[54:55], v8 offset:21504
    v_mfma_f32_32x32x16_bf16 v[92:107], v[56:59], v[44:47], v[92:107]
    ds_read_b128 v[44:47], v5 offset:0
    v_mfma_f32_32x32x16_bf16 v[108:123], v[56:59], v[48:51], v[108:123]
    ds_read_b128 v[48:51], v5 offset:4096
    ds_read_b64_tr_b16 v[56:57], v9 offset:20480
    ds_read_b64_tr_b16 v[58:59], v9 offset:21504
    s_add_u32 s34, s34, 1
    s_cmp_lt_u32 s34, 2
    s_cbranch_scc1 q_lqk
    s_waitcnt lgkmcnt(0)
    s_mov_b32 s32, 0
    v_cvt_pk_bf16_f32 v28, v60, v61
    v_cvt_pk_bf16_f32 v29, v62, v63
    v_cvt_pk_bf16_f32 v30, v64, v65
    v_cvt_pk_bf16_f32 v31, v66, v67
    buffer_store_dwordx4 v[28:31], v124, s[8:11], s32 offen offset:0 sc1
    v_cvt_pk_bf16_f32 v32, v76, v77
    v_cvt_pk_bf16_f32 v33, v78, v79
    v_cvt_pk_bf16_f32 v34, v80, v81
    v_cvt_pk_bf16_f32 v35, v82, v83
    buffer_store_dwordx4 v[32:35], v124, s[8:11], s32 offen offset:512 sc1
    s_mov_b32 s33, 65536
    v_cvt_pk_bf16_f32 v36, v68, v69
    v_cvt_pk_bf16_f32 v37, v70, v71
    v_cvt_pk_bf16_f32 v38, v72, v73
    v_cvt_pk_bf16_f32 v39, v74, v75
    buffer_store_dwordx4 v[36:39], v124, s[8:11], s33 offen offset:0 sc1
    v_cvt_pk_bf16_f32 v40, v84, v85
    v_cvt_pk_bf16_f32 v41, v86, v87
    v_cvt_pk_bf16_f32 v42, v88, v89
    v_cvt_pk_bf16_f32 v43, v90, v91
    buffer_store_dwordx4 v[40:43], v124, s[8:11], s33 offen offset:512 sc1
    s_mov_b32 s32, 131072
    v_cvt_pk_bf16_f32 v44, v92, v93
    v_cvt_pk_bf16_f32 v45, v94, v95
    v_cvt_pk_bf16_f32 v46, v96, v97
    v_cvt_pk_bf16_f32 v47, v98, v99
    buffer_store_dwordx4 v[44:47], v124, s[8:11], s32 offen offset:0 sc1
    v_cvt_pk_bf16_f32 v48, v108, v109
    v_cvt_pk_bf16_f32 v49, v110, v111
    v_cvt_pk_bf16_f32 v50, v112, v113
    v_cvt_pk_bf16_f32 v51, v114, v115
    buffer_store_dwordx4 v[48:51], v124, s[8:11], s32 offen offset:512 sc1
    s_mov_b32 s33, 196608
    v_cvt_pk_bf16_f32 v52, v100, v101
    v_cvt_pk_bf16_f32 v53, v102, v103
    v_cvt_pk_bf16_f32 v54, v104, v105
    v_cvt_pk_bf16_f32 v55, v106, v107
    buffer_store_dwordx4 v[52:55], v124, s[8:11], s33 offen offset:0 sc1
    v_cvt_pk_bf16_f32 v56, v116, v117
    v_cvt_pk_bf16_f32 v57, v118, v119
    v_cvt_pk_bf16_f32 v58, v120, v121
    v_cvt_pk_bf16_f32 v59, v122, v123
    buffer_store_dwordx4 v[56:59], v124, s[8:11], s33 offen offset:512 sc1
    s_branch q_pub
q_consV:
    v_and_b32 v1, 19, v126
    v_bfe_u32 v0, v126, 2, 1
    v_bfe_u32 v3, v126, 3, 1
    v_lshl_add_u32 v1, v0, 3, v1
    v_lshl_add_u32 v1, v3, 2, v1
    s_sub_u32 s30, s13, 10
    s_lshl_b32 s30, s30, 7
    s_lshl_b32 s31, s29, 6
    s_add_u32 s30, s30, s31
    v_add_u32 v1, s30, v1
    s_lshl_b32 s31, s12, 2
    s_lshl_b32 s32, s28, 1
    s_add_u32 s31, s31, s32
    s_mul_i32 s31, s31, 1280
    s_add_u32 s31, s31, 5242880
    s_mov_b32 s35, 81920
    v_add_u32 v28, 0, v1
    v_mul_u32_u24 v29, 3277, v28
    v_lshrrev_b32 v29, 16, v29
    v_mul_u32_u24 v30, 20, v29
    v_sub_u32 v30, v28, v30
    v_and_b32 v31, 1, v29
    v_lshlrev_b32 v31, 2, v31
    v_sub_u32 v30, v30, v31
    v_add_u32 v32, 20, v30
    v_cmp_gt_i32 vcc, 0, v30
    s_nop 1
    v_cndmask_b32 v30, v30, v32, vcc
    v_and_b32 v32, 3, v30
    v_bfe_u32 v33, v30, 2, 1
    v_bfe_u32 v34, v30, 3, 1
    v_lshl_add_u32 v32, v33, 3, v32
    v_lshl_add_u32 v32, v34, 2, v32
    v_cmp_gt_u32 vcc, 16, v30
    s_nop 1
    v_cndmask_b32 v30, v30, v32, vcc
    v_mul_lo_u32 v29, v29, s35
    v_lshl_add_u32 v29, v30, 4, v29
    v_mul_u32_u24 v31, 320, v127
    v_add3_u32 v124, v29, v31, s31
    v_add_u32 v28, 32, v1
    v_mul_u32_u24 v29, 3277, v28
    v_lshrrev_b32 v29, 16, v29
    v_mul_u32_u24 v30, 20, v29
    v_sub_u32 v30, v28, v30
    v_and_b32 v31, 1, v29
    v_lshlrev_b32 v31, 2, v31
    v_sub_u32 v30, v30, v31
    v_add_u32 v32, 20, v30
    v_cmp_gt_i32 vcc, 0, v30
    s_nop 1
    v_cndmask_b32 v30, v30, v32, vcc
    v_and_b32 v32, 3, v30
    v_bfe_u32 v33, v30, 2, 1
    v_bfe_u32 v34, v30, 3, 1
    v_lshl_add_u32 v32, v33, 3, v32
    v_lshl_add_u32 v32, v34, 2, v32
    v_cmp_gt_u32 vcc, 16, v30
    s_nop 1
    v_cndmask_b32 v30, v30, v32, vcc
    v_mul_lo_u32 v29, v29, s35
    v_lshl_add_u32 v29, v30, 4, v29
    v_mul_u32_u24 v31, 320, v127
    v_add3_u32 v125, v29, v31, s31
    s_barrier
    ds_read_b64_tr_b16 v[36:37], v8 offset:16384
    ds_read_b64_tr_b16 v[38:39], v8 offset:17408
    ds_read_b128 v[28:31], v4 offset:0
    ds_read_b128 v[32:35], v4 offset:4096
    ds_read_b64_tr_b16 v[40:41], v9 offset:16384
    ds_read_b64_tr_b16 v[42:43], v9 offset:17408
    ds_read_b64_tr_b16 v[52:53], v8 offset:20480
    ds_read_b64_tr_b16 v[54:55], v8 offset:21504
    ds_read_b128 v[44:47], v5 offset:0
    ds_read_b128 v[48:51], v5 offset:4096
    ds_read_b64_tr_b16 v[56:57], v9 offset:20480
    ds_read_b64_tr_b16 v[58:59], v9 offset:21504
    s_waitcnt lgkmcnt(0)
    s_mov_b32 s34, 0
.p2align 3
q_lv:
    s_waitcnt lgkmcnt(9)
    v_mfma_f32_32x32x16_bf16 v[60:75], v[28:31], v[36:39], v[60:75]
    s_waitcnt lgkmcnt(8)
    v_mfma_f32_32x32x16_bf16 v[76:91], v[32:35], v[36:39], v[76:91]
    ds_read_b64_tr_b16 v[36:37], v8 offset:24576
    ds_read_b64_tr_b16 v[38:39], v8 offset:25600
    s_waitcnt lgkmcnt(8)
    v_mfma_f32_32x32x16_bf16 v[92:107], v[28:31], v[40:43], v[92:107]
    ds_read_b128 v[28:31], v6 offset:0
    v_mfma_f32_32x32x16_bf16 v[108:123], v[32:35], v[40:43], v[108:123]
    ds_read_b128 v[32:35], v6 offset:4096
    ds_read_b64_tr_b16 v[40:41], v9 offset:24576
    ds_read_b64_tr_b16 v[42:43], v9 offset:25600
    s_waitcnt lgkmcnt(9)
    v_mfma_f32_32x32x16_bf16 v[60:75], v[44:47], v[52:55], v[60:75]
    s_waitcnt lgkmcnt(8)
    v_mfma_f32_32x32x16_bf16 v[76:91], v[48:51], v[52:55], v[76:91]
    ds_read_b64_tr_b16 v[52:53], v8 offset:28672
    ds_read_b64_tr_b16 v[54:55], v8 offset:29696
    s_waitcnt lgkmcnt(8)
    v_mfma_f32_32x32x16_bf16 v[92:107], v[44:47], v[56:59], v[92:107]
    ds_read_b128 v[44:47], v7 offset:0
    v_mfma_f32_32x32x16_bf16 v[108:123], v[48:51], v[56:59], v[108:123]
    ds_read_b128 v[48:51], v7 offset:4096
    ds_read_b64_tr_b16 v[56:57], v9 offset:28672
    ds_read_b64_tr_b16 v[58:59], v9 offset:29696
    s_waitcnt lgkmcnt(9)
    v_mfma_f32_32x32x16_bf16 v[60:75], v[28:31], v[36:39], v[60:75]
    s_waitcnt lgkmcnt(8)
    v_mfma_f32_32x32x16_bf16 v[76:91], v[32:35], v[36:39], v[76:91]
    s_waitcnt lgkmcnt(0)
    s_barrier
    ds_read_b64_tr_b16 v[36:37], v14 offset:0
    ds_read_b64_tr_b16 v[38:39], v14 offset:1024
    v_mfma_f32_32x32x16_bf16 v[92:107], v[28:31], v[40:43], v[92:107]
    ds_read_b128 v[28:31], v4 offset:32768
    v_mfma_f32_32x32x16_bf16 v[108:123], v[32:35], v[40:43], v[108:123]
    ds_read_b128 v[32:35], v4 offset:36864
    ds_read_b64_tr_b16 v[40:41], v15 offset:0
    ds_read_b64_tr_b16 v[42:43], v15 offset:1024
    v_mfma_f32_32x32x16_bf16 v[60:75], v[44:47], v[52:55], v[60:75]
    v_mfma_f32_32x32x16_bf16 v[76:91], v[48:51], v[52:55], v[76:91]
    ds_read_b64_tr_b16 v[52:53], v14 offset:4096
    ds_read_b64_tr_b16 v[54:55], v14 offset:5120
    v_mfma_f32_32x32x16_bf16 v[92:107], v[44:47], v[56:59], v[92:107]
    ds_read_b128 v[44:47], v5 offset:32768
    v_mfma_f32_32x32x16_bf16 v[108:123], v[48:51], v[56:59], v[108:123]
    ds_read_b128 v[48:51], v5 offset:36864
    ds_read_b64_tr_b16 v[56:57], v15 offset:4096
    ds_read_b64_tr_b16 v[58:59], v15 offset:5120
    s_waitcnt lgkmcnt(9)
    v_mfma_f32_32x32x16_bf16 v[60:75], v[28:31], v[36:39], v[60:75]
    s_waitcnt lgkmcnt(8)
    v_mfma_f32_32x32x16_bf16 v[76:91], v[32:35], v[36:39], v[76:91]
    ds_read_b64_tr_b16 v[36:37], v14 offset:8192
    ds_read_b64_tr_b16 v[38:39], v14 offset:9216
    s_waitcnt lgkmcnt(8)
    v_mfma_f32_32x32x16_bf16 v[92:107], v[28:31], v[40:43], v[92:107]
    ds_read_b128 v[28:31], v6 offset:32768
    v_mfma_f32_32x32x16_bf16 v[108:123], v[32:35], v[40:43], v[108:123]
    ds_read_b128 v[32:35], v6 offset:36864
    ds_read_b64_tr_b16 v[40:41], v15 offset:8192
    ds_read_b64_tr_b16 v[42:43], v15 offset:9216
    s_waitcnt lgkmcnt(9)
    v_mfma_f32_32x32x16_bf16 v[60:75], v[44:47], v[52:55], v[60:75]
    s_waitcnt lgkmcnt(8)
    v_mfma_f32_32x32x16_bf16 v[76:91], v[48:51], v[52:55], v[76:91]
    ds_read_b64_tr_b16 v[52:53], v14 offset:12288
    ds_read_b64_tr_b16 v[54:55], v14 offset:13312
    s_waitcnt lgkmcnt(8)
    v_mfma_f32_32x32x16_bf16 v[92:107], v[44:47], v[56:59], v[92:107]
    ds_read_b128 v[44:47], v7 offset:32768
    v_mfma_f32_32x32x16_bf16 v[108:123], v[48:51], v[56:59], v[108:123]
    ds_read_b128 v[48:51], v7 offset:36864
    ds_read_b64_tr_b16 v[56:57], v15 offset:12288
    ds_read_b64_tr_b16 v[58:59], v15 offset:13312
    s_waitcnt lgkmcnt(9)
    v_mfma_f32_32x32x16_bf16 v[60:75], v[28:31], v[36:39], v[60:75]
    s_waitcnt lgkmcnt(8)
    v_mfma_f32_32x32x16_bf16 v[76:91], v[32:35], v[36:39], v[76:91]
    s_waitcnt lgkmcnt(0)
    s_barrier
    ds_read_b64_tr_b16 v[36:37], v8 offset:0
    ds_read_b64_tr_b16 v[38:39], v8 offset:1024
    v_mfma_f32_32x32x16_bf16 v[92:107], v[28:31], v[40:43], v[92:107]
    ds_read_b128 v[28:31], v10 offset:16384
    v_mfma_f32_32x32x16_bf16 v[108:123], v[32:35], v[40:43], v[108:123]
    ds_read_b128 v[32:35], v10 offset:20480
    ds_read_b64_tr_b16 v[40:41], v9 offset:0
    ds_read_b64_tr_b16 v[42:43], v9 offset:1024
    v_mfma_f32_32x32x16_bf16 v[60:75], v[44:47], v[52:55], v[60:75]
    v_mfma_f32_32x32x16_bf16 v[76:91], v[48:51], v[52:55], v[76:91]
    ds_read_b64_tr_b16 v[52:53], v8 offset:4096
    ds_read_b64_tr_b16 v[54:55], v8 offset:5120
    v_mfma_f32_32x32x16_bf16 v[92:107], v[44:47], v[56:59], v[92:107]
    ds_read_b128 v[44:47], v11 offset:16384
    v_mfma_f32_32x32x16_bf16 v[108:123], v[48:51], v[56:59], v[108:123]
    ds_read_b128 v[48:51], v11 offset:20480
    ds_read_b64_tr_b16 v[56:57], v9 offset:4096
    ds_read_b64_tr_b16 v[58:59], v9 offset:5120
    s_waitcnt lgkmcnt(9)
    v_mfma_f32_32x32x16_bf16 v[60:75], v[28:31], v[36:39], v[60:75]
    s_waitcnt lgkmcnt(8)
    v_mfma_f32_32x32x16_bf16 v[76:91], v[32:35], v[36:39], v[76:91]
    ds_read_b64_tr_b16 v[36:37], v8 offset:8192
    ds_read_b64_tr_b16 v[38:39], v8 offset:9216
    s_waitcnt lgkmcnt(8)
    v_mfma_f32_32x32x16_bf16 v[92:107], v[28:31], v[40:43], v[92:107]
    ds_read_b128 v[28:31], v12 offset:16384
    v_mfma_f32_32x32x16_bf16 v[108:123], v[32:35], v[40:43], v[108:123]
    ds_read_b128 v[32:35], v12 offset:20480
    ds_read_b64_tr_b16 v[40:41], v9 offset:8192
    ds_read_b64_tr_b16 v[42:43], v9 offset:9216
    s_waitcnt lgkmcnt(9)
    v_mfma_f32_32x32x16_bf16 v[60:75], v[44:47], v[52:55], v[60:75]
    s_waitcnt lgkmcnt(8)
    v_mfma_f32_32x32x16_bf16 v[76:91], v[48:51], v[52:55], v[76:91]
    ds_read_b64_tr_b16 v[52:53], v8 offset:12288
    ds_read_b64_tr_b16 v[54:55], v8 offset:13312
    s_waitcnt lgkmcnt(8)
    v_mfma_f32_32x32x16_bf16 v[92:107], v[44:47], v[56:59], v[92:107]
    ds_read_b128 v[44:47], v13 offset:16384
    v_mfma_f32_32x32x16_bf16 v[108:123], v[48:51], v[56:59], v[108:123]
    ds_read_b128 v[48:51], v13 offset:20480
    ds_read_b64_tr_b16 v[56:57], v9 offset:12288
    ds_read_b64_tr_b16 v[58:59], v9 offset:13312
    s_waitcnt lgkmcnt(9)
    v_mfma_f32_32x32x16_bf16 v[60:75], v[28:31], v[36:39], v[60:75]
    s_waitcnt lgkmcnt(8)
    v_mfma_f32_32x32x16_bf16 v[76:91], v[32:35], v[36:39], v[76:91]
    s_waitcnt lgkmcnt(0)
    s_barrier
    ds_read_b64_tr_b16 v[36:37], v8 offset:32768
    ds_read_b64_tr_b16 v[38:39], v8 offset:33792
    v_mfma_f32_32x32x16_bf16 v[92:107], v[28:31], v[40:43], v[92:107]
    ds_read_b128 v[28:31], v4 offset:16384
    v_mfma_f32_32x32x16_bf16 v[108:123], v[32:35], v[40:43], v[108:123]
    ds_read_b128 v[32:35], v4 offset:20480
    ds_read_b64_tr_b16 v[40:41], v9 offset:32768
    ds_read_b64_tr_b16 v[42:43], v9 offset:33792
    v_mfma_f32_32x32x16_bf16 v[60:75], v[44:47], v[52:55], v[60:75]
    v_mfma_f32_32x32x16_bf16 v[76:91], v[48:51], v[52:55], v[76:91]
    ds_read_b64_tr_b16 v[52:53], v8 offset:36864
    ds_read_b64_tr_b16 v[54:55], v8 offset:37888
    v_mfma_f32_32x32x16_bf16 v[92:107], v[44:47], v[56:59], v[92:107]
    ds_read_b128 v[44:47], v5 offset:16384
    v_mfma_f32_32x32x16_bf16 v[108:123], v[48:51], v[56:59], v[108:123]
    ds_read_b128 v[48:51], v5 offset:20480
    ds_read_b64_tr_b16 v[56:57], v9 offset:36864
    ds_read_b64_tr_b16 v[58:59], v9 offset:37888
    s_waitcnt lgkmcnt(9)
    v_mfma_f32_32x32x16_bf16 v[60:75], v[28:31], v[36:39], v[60:75]
    s_waitcnt lgkmcnt(8)
    v_mfma_f32_32x32x16_bf16 v[76:91], v[32:35], v[36:39], v[76:91]
    ds_read_b64_tr_b16 v[36:37], v8 offset:40960
    ds_read_b64_tr_b16 v[38:39], v8 offset:41984
    s_waitcnt lgkmcnt(8)
    v_mfma_f32_32x32x16_bf16 v[92:107], v[28:31], v[40:43], v[92:107]
    ds_read_b128 v[28:31], v6 offset:16384
    v_mfma_f32_32x32x16_bf16 v[108:123], v[32:35], v[40:43], v[108:123]
    ds_read_b128 v[32:35], v6 offset:20480
    ds_read_b64_tr_b16 v[40:41], v9 offset:40960
    ds_read_b64_tr_b16 v[42:43], v9 offset:41984
    s_waitcnt lgkmcnt(9)
    v_mfma_f32_32x32x16_bf16 v[60:75], v[44:47], v[52:55], v[60:75]
    s_waitcnt lgkmcnt(8)
    v_mfma_f32_32x32x16_bf16 v[76:91], v[48:51], v[52:55], v[76:91]
    ds_read_b64_tr_b16 v[52:53], v8 offset:45056
    ds_read_b64_tr_b16 v[54:55], v8 offset:46080
    s_waitcnt lgkmcnt(8)
    v_mfma_f32_32x32x16_bf16 v[92:107], v[44:47], v[56:59], v[92:107]
    ds_read_b128 v[44:47], v7 offset:16384
    v_mfma_f32_32x32x16_bf16 v[108:123], v[48:51], v[56:59], v[108:123]
    ds_read_b128 v[48:51], v7 offset:20480
    ds_read_b64_tr_b16 v[56:57], v9 offset:45056
    ds_read_b64_tr_b16 v[58:59], v9 offset:46080
    s_waitcnt lgkmcnt(9)
    v_mfma_f32_32x32x16_bf16 v[60:75], v[28:31], v[36:39], v[60:75]
    s_waitcnt lgkmcnt(8)
    v_mfma_f32_32x32x16_bf16 v[76:91], v[32:35], v[36:39], v[76:91]
    s_waitcnt lgkmcnt(0)
    s_barrier
    ds_read_b64_tr_b16 v[36:37], v14 offset:16384
    ds_read_b64_tr_b16 v[38:39], v14 offset:17408
    v_mfma_f32_32x32x16_bf16 v[92:107], v[28:31], v[40:43], v[92:107]
    ds_read_b128 v[28:31], v10 offset:0
    v_mfma_f32_32x32x16_bf16 v[108:123], v[32:35], v[40:43], v[108:123]
    ds_read_b128 v[32:35], v10 offset:4096
    ds_read_b64_tr_b16 v[40:41], v15 offset:16384
    ds_read_b64_tr_b16 v[42:43], v15 offset:17408
    v_mfma_f32_32x32x16_bf16 v[60:75], v[44:47], v[52:55], v[60:75]
    v_mfma_f32_32x32x16_bf16 v[76:91], v[48:51], v[52:55], v[76:91]
    ds_read_b64_tr_b16 v[52:53], v14 offset:20480
    ds_read_b64_tr_b16 v[54:55], v14 offset:21504
    v_mfma_f32_32x32x16_bf16 v[92:107], v[44:47], v[56:59], v[92:107]
    ds_read_b128 v[44:47], v11 offset:0
    v_mfma_f32_32x32x16_bf16 v[108:123], v[48:51], v[56:59], v[108:123]
    ds_read_b128 v[48:51], v11 offset:4096
    ds_read_b64_tr_b16 v[56:57], v15 offset:20480
    ds_read_b64_tr_b16 v[58:59], v15 offset:21504
    s_waitcnt lgkmcnt(9)
    v_mfma_f32_32x32x16_bf16 v[60:75], v[28:31], v[36:39], v[60:75]
    s_waitcnt lgkmcnt(8)
    v_mfma_f32_32x32x16_bf16 v[76:91], v[32:35], v[36:39], v[76:91]
    ds_read_b64_tr_b16 v[36:37], v14 offset:24576
    ds_read_b64_tr_b16 v[38:39], v14 offset:25600
    s_waitcnt lgkmcnt(8)
    v_mfma_f32_32x32x16_bf16 v[92:107], v[28:31], v[40:43], v[92:107]
    ds_read_b128 v[28:31], v12 offset:0
    v_mfma_f32_32x32x16_bf16 v[108:123], v[32:35], v[40:43], v[108:123]
    ds_read_b128 v[32:35], v12 offset:4096
    ds_read_b64_tr_b16 v[40:41], v15 offset:24576
    ds_read_b64_tr_b16 v[42:43], v15 offset:25600
    s_waitcnt lgkmcnt(9)
    v_mfma_f32_32x32x16_bf16 v[60:75], v[44:47], v[52:55], v[60:75]
    s_waitcnt lgkmcnt(8)
    v_mfma_f32_32x32x16_bf16 v[76:91], v[48:51], v[52:55], v[76:91]
    ds_read_b64_tr_b16 v[52:53], v14 offset:28672
    ds_read_b64_tr_b16 v[54:55], v14 offset:29696
    s_waitcnt lgkmcnt(8)
    v_mfma_f32_32x32x16_bf16 v[92:107], v[44:47], v[56:59], v[92:107]
    ds_read_b128 v[44:47], v13 offset:0
    v_mfma_f32_32x32x16_bf16 v[108:123], v[48:51], v[56:59], v[108:123]
    ds_read_b128 v[48:51], v13 offset:4096
    ds_read_b64_tr_b16 v[56:57], v15 offset:28672
    ds_read_b64_tr_b16 v[58:59], v15 offset:29696
    s_waitcnt lgkmcnt(9)
    v_mfma_f32_32x32x16_bf16 v[60:75], v[28:31], v[36:39], v[60:75]
    s_waitcnt lgkmcnt(8)
    v_mfma_f32_32x32x16_bf16 v[76:91], v[32:35], v[36:39], v[76:91]
    s_waitcnt lgkmcnt(0)
    s_barrier
    ds_read_b64_tr_b16 v[36:37], v8 offset:16384
    ds_read_b64_tr_b16 v[38:39], v8 offset:17408
    v_mfma_f32_32x32x16_bf16 v[92:107], v[28:31], v[40:43], v[92:107]
    ds_read_b128 v[28:31], v4 offset:0
    v_mfma_f32_32x32x16_bf16 v[108:123], v[32:35], v[40:43], v[108:123]
    ds_read_b128 v[32:35], v4 offset:4096
    ds_read_b64_tr_b16 v[40:41], v9 offset:16384
    ds_read_b64_tr_b16 v[42:43], v9 offset:17408
    v_mfma_f32_32x32x16_bf16 v[60:75], v[44:47], v[52:55], v[60:75]
    v_mfma_f32_32x32x16_bf16 v[76:91], v[48:51], v[52:55], v[76:91]
    ds_read_b64_tr_b16 v[52:53], v8 offset:20480
    ds_read_b64_tr_b16 v[54:55], v8 offset:21504
    v_mfma_f32_32x32x16_bf16 v[92:107], v[44:47], v[56:59], v[92:107]
    ds_read_b128 v[44:47], v5 offset:0
    v_mfma_f32_32x32x16_bf16 v[108:123], v[48:51], v[56:59], v[108:123]
    ds_read_b128 v[48:51], v5 offset:4096
    ds_read_b64_tr_b16 v[56:57], v9 offset:20480
    ds_read_b64_tr_b16 v[58:59], v9 offset:21504
    s_add_u32 s34, s34, 1
    s_cmp_lt_u32 s34, 2
    s_cbranch_scc1 q_lv
    s_waitcnt lgkmcnt(0)
    v_cvt_pk_bf16_f32 v28, v60, v61
    v_cvt_pk_bf16_f32 v29, v62, v63
    v_cvt_pk_bf16_f32 v30, v64, v65
    v_cvt_pk_bf16_f32 v31, v66, v67
    buffer_store_dwordx4 v[28:31], v124, s[8:11], 0 offen offset:0 sc1
    v_cvt_pk_bf16_f32 v32, v68, v69
    v_cvt_pk_bf16_f32 v33, v70, v71
    v_cvt_pk_bf16_f32 v34, v72, v73
    v_cvt_pk_bf16_f32 v35, v74, v75
    buffer_store_dwordx4 v[32:35], v124, s[8:11], 0 offen offset:640 sc1
    v_cvt_pk_bf16_f32 v36, v76, v77
    v_cvt_pk_bf16_f32 v37, v78, v79
    v_cvt_pk_bf16_f32 v38, v80, v81
    v_cvt_pk_bf16_f32 v39, v82, v83
    buffer_store_dwordx4 v[36:39], v124, s[8:11], 0 offen offset:1280 sc1
    v_cvt_pk_bf16_f32 v40, v84, v85
    v_cvt_pk_bf16_f32 v41, v86, v87
    v_cvt_pk_bf16_f32 v42, v88, v89
    v_cvt_pk_bf16_f32 v43, v90, v91
    buffer_store_dwordx4 v[40:43], v124, s[8:11], 0 offen offset:1920 sc1
    v_cvt_pk_bf16_f32 v44, v92, v93
    v_cvt_pk_bf16_f32 v45, v94, v95
    v_cvt_pk_bf16_f32 v46, v96, v97
    v_cvt_pk_bf16_f32 v47, v98, v99
    buffer_store_dwordx4 v[44:47], v125, s[8:11], 0 offen offset:0 sc1
    v_cvt_pk_bf16_f32 v48, v100, v101
    v_cvt_pk_bf16_f32 v49, v102, v103
    v_cvt_pk_bf16_f32 v50, v104, v105
    v_cvt_pk_bf16_f32 v51, v106, v107
    buffer_store_dwordx4 v[48:51], v125, s[8:11], 0 offen offset:640 sc1
    v_cvt_pk_bf16_f32 v52, v108, v109
    v_cvt_pk_bf16_f32 v53, v110, v111
    v_cvt_pk_bf16_f32 v54, v112, v113
    v_cvt_pk_bf16_f32 v55, v114, v115
    buffer_store_dwordx4 v[52:55], v125, s[8:11], 0 offen offset:1280 sc1
    v_cvt_pk_bf16_f32 v56, v116, v117
    v_cvt_pk_bf16_f32 v57, v118, v119
    v_cvt_pk_bf16_f32 v58, v120, v121
    v_cvt_pk_bf16_f32 v59, v122, v123
    buffer_store_dwordx4 v[56:59], v125, s[8:11], 0 offen offset:1920 sc1
q_pub:
    s_mov_b32 s81, 1
    s_branch m_att
m_noq:
    s_load_dwordx4 s[24:27], s[0:1], 72
    s_waitcnt lgkmcnt(0)
    s_add_u32 s6, s4, 12517376
    s_addc_u32 s7, s5, 0
    s_load_dword s80, s[6:7], 0
    s_mov_b32 s8, s4
    s_and_b32 s9, s5, 0xffff
    s_mov_b32 s10, 0x1600000
    s_mov_b32 s11, 0x00020000
    s_mov_b32 s92, s88
    s_and_b32 s93, s89, 0xffff
    s_mov_b32 s94, 0xa00000
    s_mov_b32 s95, 0x00020000
    s_mov_b32 s84, s90
    s_and_b32 s85, s91, 0xffff
    s_mov_b32 s86, 0x100
    s_mov_b32 s87, 0x00020000
    s_waitcnt vmcnt(0) lgkmcnt(0)
    s_add_u32 s80, s80, 1
    s_sleep 100
m_att:
    s_and_b32 s12, s2, 7
    s_bfe_u32 s13, s2, 0x50003
    s_lshl_b32 s12, s12, 2
    s_and_b32 s17, s13, 3
    s_add_u32 s12, s12, s17
    s_lshr_b32 s13, s13, 2
    s_and_b32 s15, s14, 3
    s_lshr_b32 s16, s14, 2
    s_lshr_b32 s28, s12, 1
    s_and_b32 s29, s12, 1
    s_mul_i32 s30, s28, 5
    s_mul_i32 s31, s29, 3
    s_add_u32 s31, s31, s30
    s_add_u32 s30, s30, 2
    v_lshlrev_b32 v111, 4, v2
    s_mul_i32 s24, s14, 3072
    s_cmp_ge_u32 s14, 4
    s_cbranch_scc1 a_vsrc
    s_mul_i32 s33, s14, 3
    s_add_u32 s33, s33, 0
    s_lshr_b32 s34, s33, 2
    s_and_b32 s33, s33, 3
    s_add_u32 s35, s31, s34
    s_cmp_eq_u32 s34, 2
    s_cselect_b32 s35, s30, s35
    s_add_u32 s35, s35, 80
    s_lshl_b32 s35, s35, 15
    s_lshl_b32 s33, s33, 10
    s_add_u32 s35, s35, s33
    s_add_u32 s20, s35, 0
    s_mul_i32 s33, s14, 3
    s_add_u32 s33, s33, 1
    s_lshr_b32 s34, s33, 2
    s_and_b32 s33, s33, 3
    s_add_u32 s35, s31, s34
    s_cmp_eq_u32 s34, 2
    s_cselect_b32 s35, s30, s35
    s_add_u32 s35, s35, 80
    s_lshl_b32 s35, s35, 15
    s_lshl_b32 s33, s33, 10
    s_add_u32 s35, s35, s33
    s_add_u32 s21, s35, -1024
    s_mul_i32 s33, s14, 3
    s_add_u32 s33, s33, 2
    s_lshr_b32 s34, s33, 2
    s_and_b32 s33, s33, 3
    s_add_u32 s35, s31, s34
    s_cmp_eq_u32 s34, 2
    s_cselect_b32 s35, s30, s35
    s_add_u32 s35, s35, 80
    s_lshl_b32 s35, s35, 15
    s_lshl_b32 s33, s33, 10
    s_add_u32 s35, s35, s33
    s_add_u32 s22, s35, -2048
    s_movk_i32 s23, 4096
    s_branch a_srcdone
a_vsrc:
    s_mul_i32 s33, s12, 81920
    s_add_u32 s33, s33, s24
    s_add_u32 s20, s33, 5230592
    s_cmp_eq_u32 s14, 7
    s_cselect_b32 s33, 1024, 0
    s_sub_u32 s21, s20, s33
    s_sub_u32 s22, s21, s33
    s_movk_i32 s23, 10240
a_srcdone:
    v_and_b32 v112, 31, v2
    v_lshrrev_b32 v113, 5, v2
    s_lshl_b32 s33, s13, 8
    s_lshl_b32 s34, s15, 6
    s_add_u32 s33, s33, s34
    s_mul_i32 s33, s33, 16
    v_lshl_add_u32 v114, v112, 4, s33
    v_lshrrev_b32 v115, 4, v112
    v_mul_u32_u24 v115, 0, v115
    v_add_u32 v114, v114, v115
    v_mul_u32_u24 v115, 32768, v113
    v_add_u32 v115, v115, v114
    s_lshl_b32 s32, s31, 15
    s_mul_i32 s35, s30, 32768
    s_lshl_b32 s36, s29, 3
    s_add_u32 s35, s35, s36
    s_lshl_b32 s33, s16, 11
    v_lshlrev_b32 v108, 12, v113
    v_lshl_add_u32 v108, v112, 4, v108
    v_add_u32 v108, s33, v108
    s_add_u32 s34, s33, s36
    s_add_u32 s34, s34, 8192
    v_add_u32 v109, s34, v111
    s_mul_i32 s33, s16, 5120
    s_add_u32 s33, s33, 12288
    v_mul_u32_u24 v110, 320, v113
    v_lshl_add_u32 v110, v112, 4, v110
    v_add_u32 v110, s33, v110
    s_mov_b32 s18, 0x000fffff
    s_mov_b32 s19, 0x000fffff
    v_mov_b32 v116, 0x3f803f80
    v_cmp_eq_u32 vcc, 20, v112
    s_nop 1
    v_cndmask_b32 v117, 0, v116, vcc
    v_mov_b32 v100, v117
    v_mov_b32 v101, v117
    v_mov_b32 v102, v117
    v_mov_b32 v103, v117
    v_mov_b32 v104, v117
    v_mov_b32 v105, v117
    v_mov_b32 v106, v117
    v_mov_b32 v107, v117
    v_mov_b32 v20, 0
    v_mov_b32 v21, 0
    v_mov_b32 v22, 0
    v_mov_b32 v23, 0
    v_mov_b32 v24, 0
    v_mov_b32 v25, 0
    v_mov_b32 v26, 0
    v_mov_b32 v27, 0
    v_mov_b32 v28, 0
    v_mov_b32 v29, 0
    v_mov_b32 v30, 0
    v_mov_b32 v31, 0
    v_mov_b32 v32, 0
    v_mov_b32 v33, 0
    v_mov_b32 v34, 0
    v_mov_b32 v35, 0
    v_mov_b32 v36, 0
    v_mov_b32 v37, 0
    v_mov_b32 v38, 0
    v_mov_b32 v39, 0
    v_mov_b32 v40, 0
    v_mov_b32 v41, 0
    v_mov_b32 v42, 0
    v_mov_b32 v43, 0
    v_mov_b32 v44, 0
    v_mov_b32 v45, 0
    v_mov_b32 v46, 0
    v_mov_b32 v47, 0
    v_mov_b32 v48, 0
    v_mov_b32 v49, 0
    v_mov_b32 v50, 0
    v_mov_b32 v51, 0
    v_mov_b32 v84, 0
    v_mov_b32 v85, 0
    v_mov_b32 v86, 0
    v_mov_b32 v87, 0
    v_mov_b32 v88, 0
    v_mov_b32 v89, 0
    v_mov_b32 v90, 0
    v_mov_b32 v91, 0
    v_mov_b32 v80, 0
    v_mov_b32 v81, 0
    v_mov_b32 v82, 0
    v_mov_b32 v83, 0
    s_lshl_b32 s33, s15, 10
    s_add_u32 s33, s33, 49152
    v_lshl_add_u32 v92, v112, 4, s33
    v_lshl_add_u32 v93, v113, 12, v92
    v_add_u32 v92, s36, v92
    v_mov_b32 v94, 73728
    s_mul_i32 s69, s23, -7
    s_cmp_eq_u32 s81, 0
    s_cbranch_scc1 a_nopub
    s_waitcnt vmcnt(0)
    s_mov_b64 exec, s[74:75]
    buffer_store_dword v17, v16, s[8:11], 0 offen sc1
    s_mov_b64 exec, -1
a_nopub:
    s_load_dwordx2 s[82:83], s[0:1], 88
    v_lshrrev_b32 v98, 3, v2
    v_mul_u32_u24 v98, 1280, v98
    v_and_b32 v99, 7, v2
    v_bfe_u32 v3, v2, 4, 1
    v_lshlrev_b32 v3, 2, v3
    v_xor_b32 v99, v99, v3
    v_lshl_add_u32 v98, v99, 4, v98
    s_and_b32 s73, s14, 1
    s_lshl_b32 s73, s73, 5
    v_xor_b32 v98, s73, v98
    v_xor_b32 v99, 32, v98
    s_sub_u32 s73, s71, 12
    s_lshr_b32 s73, s73, 1
    s_lshl_b32 s73, s73, 7
    s_waitcnt lgkmcnt(0)
    s_mov_b32 s76, s82
    s_and_b32 s77, s83, 0xffff
    s_mov_b32 s78, 0xc8000
    s_mov_b32 s79, 0x00020000
    s_mov_b32 s38, 0
    s_cmp_lg_u32 s14, 4
    s_cbranch_scc1 a_wait
    s_mul_i32 s33, s12, 20
    s_lshr_b32 s34, s33, 6
    s_add_u32 s33, s33, 19
    s_lshr_b32 s33, s33, 6
    s_cmp_eq_u32 s33, s34
    s_cselect_b32 s33, 1, 0x101
    s_lshl_b32 s42, s33, s13
    s_mul_i32 s75, s33, 0xff
    s_lshl_b32 s74, s75, 16
    s_mul_i32 s72, s12, 4864
    s_add_u32 s72, s72, 11534336
    s_mov_b32 s38, 1
    s_mov_b32 s43, 0
    s_sleep 45
a_fp:
    buffer_load_dwordx4 v[116:119], v111, s[8:11], s72 offen sc1
    s_add_u32 s43, s43, 1
    s_waitcnt vmcnt(0)
    v_xor_b32 v116, s80, v116
    v_xor_b32 v117, s80, v117
    v_xor_b32 v118, s80, v118
    v_xor_b32 v119, s80, v119
    v_or3_b32 v116, v116, v117, v118
    v_or_b32 v116, v116, v119
    v_cmp_ne_u32 vcc, 0, v116
    s_nop 0
    s_and_b64 s[40:41], vcc, s[74:75]
    s_lshr_b32 s40, s40, 16
    s_or_b32 s40, s40, s41
    s_lshr_b32 s41, s40, 8
    s_or_b32 s40, s40, s41
    s_andn2_b32 s40, 0xff, s40
    s_lshr_b32 s41, s40, 1
    s_lshl_b32 s33, s40, 7
    s_or_b32 s41, s41, s33
    s_and_b32 s40, s40, s41
    s_ff1_i32_b32 s68, s40
    s_and_b32 s41, vcc_lo, s42
    s_cselect_b32 s40, 0, s40
    s_cmp_lg_u32 s40, 0
    s_cbranch_scc1 a_fp_d
    s_sleep 16
    s_cmp_lt_u32 s43, 200000
    s_cbranch_scc1 a_fp
a_fp_d:
    s_and_b32 s68, s68, 7
    s_lshl_b32 s33, s13, 12
    s_lshl_b32 s34, s68, 12
    s_add_u32 s37, s31, 0
    s_lshl_b32 s37, s37, 15
    s_add_u32 s39, s37, s33
    s_mov_b32 m0, 49152
    s_nop 0
    buffer_load_dwordx4 v111, s[8:11], s39 offen offset:0 lds
    buffer_load_dwordx4 v111, s[8:11], s39 offen offset:1024 lds
    buffer_load_dwordx4 v111, s[8:11], s39 offen offset:2048 lds
    buffer_load_dwordx4 v111, s[8:11], s39 offen offset:3072 lds
    s_add_u32 s39, s37, s34
    s_add_u32 s39, s39, 2621440
    s_mov_b32 m0, 0
    s_nop 0
    buffer_load_dwordx4 v111, s[8:11], s39 offen offset:0 lds
    buffer_load_dwordx4 v111, s[8:11], s39 offen offset:1024 lds
    buffer_load_dwordx4 v111, s[8:11], s39 offen offset:2048 lds
    buffer_load_dwordx4 v111, s[8:11], s39 offen offset:3072 lds
    s_add_u32 s37, s31, 1
    s_lshl_b32 s37, s37, 15
    s_add_u32 s39, s37, s33
    s_mov_b32 m0, 53248
    s_nop 0
    buffer_load_dwordx4 v111, s[8:11], s39 offen offset:0 lds
    buffer_load_dwordx4 v111, s[8:11], s39 offen offset:1024 lds
    buffer_load_dwordx4 v111, s[8:11], s39 offen offset:2048 lds
    buffer_load_dwordx4 v111, s[8:11], s39 offen offset:3072 lds
    s_add_u32 s39, s37, s34
    s_add_u32 s39, s39, 2621440
    s_mov_b32 m0, 4096
    s_nop 0
    buffer_load_dwordx4 v111, s[8:11], s39 offen offset:0 lds
    buffer_load_dwordx4 v111, s[8:11], s39 offen offset:1024 lds
    buffer_load_dwordx4 v111, s[8:11], s39 offen offset:2048 lds
    buffer_load_dwordx4 v111, s[8:11], s39 offen offset:3072 lds
    s_mov_b32 s37, s30
    s_lshl_b32 s37, s37, 15
    s_add_u32 s39, s37, s33
    s_mov_b32 m0, 57344
    s_nop 0
    buffer_load_dwordx4 v111, s[8:11], s39 offen offset:0 lds
    buffer_load_dwordx4 v111, s[8:11], s39 offen offset:1024 lds
    buffer_load_dwordx4 v111, s[8:11], s39 offen offset:2048 lds
    buffer_load_dwordx4 v111, s[8:11], s39 offen offset:3072 lds
    s_add_u32 s39, s37, s34
    s_add_u32 s39, s39, 2621440
    s_mov_b32 m0, 8192
    s_nop 0
    buffer_load_dwordx4 v111, s[8:11], s39 offen offset:0 lds
    buffer_load_dwordx4 v111, s[8:11], s39 offen offset:1024 lds
    buffer_load_dwordx4 v111, s[8:11], s39 offen offset:2048 lds
    buffer_load_dwordx4 v111, s[8:11], s39 offen offset:3072 lds
    s_mul_i32 s39, s12, 81920
    s_mul_i32 s34, s68, 10240
    s_add_u32 s39, s39, s34
    s_add_u32 s39, s39, 5242880
    s_mov_b32 m0, 12288
    s_nop 0
    buffer_load_dwordx4 v111, s[8:11], s39 offen offset:0 lds
    buffer_load_dwordx4 v111, s[8:11], s39 offen offset:1024 lds
    buffer_load_dwordx4 v111, s[8:11], s39 offen offset:2048 lds
    buffer_load_dwordx4 v111, s[8:11], s39 offen offset:3072 lds
    s_add_u32 s39, s39, 4096
    s_mov_b32 m0, 16384
    s_nop 0
    buffer_load_dwordx4 v111, s[8:11], s39 offen offset:0 lds
    buffer_load_dwordx4 v111, s[8:11], s39 offen offset:1024 lds
    buffer_load_dwordx4 v111, s[8:11], s39 offen offset:2048 lds
    buffer_load_dwordx4 v111, s[8:11], s39 offen offset:3072 lds
    s_add_u32 s39, s39, 4096
    s_mov_b32 m0, 20480
    s_nop 0
    buffer_load_dwordx4 v111, s[8:11], s39 offen offset:0 lds
    buffer_load_dwordx4 v111, s[8:11], s39 offen offset:1024 lds
    v_mov_b32 v118, 73728
    v_mov_b32 v119, s68
    ds_write_b32 v118, v119
    v_mov_b32 v119, 0
    ds_write_b32 v118, v119 offset:4
    s_waitcnt vmcnt(0) lgkmcnt(0)
a_wait:
    s_barrier
    ds_read_b32 v95, v94
    ds_read_b128 v[52:55], v93 offset:0
    ds_read_b64 v[56:57], v92 offset:8192
    ds_read_b128 v[60:63], v93 offset:512
    ds_read_b64 v[64:65], v92 offset:8704
    s_waitcnt lgkmcnt(4)
    v_readfirstlane_b32 s68, v95
    s_nop 0
    s_add_u32 s68, s68, 1
    s_and_b32 s68, s68, 7
    s_mul_i32 s33, s68, s23
    s_add_u32 s20, s20, s33
    s_add_u32 s21, s21, s33
    s_add_u32 s22, s22, s33
    s_add_u32 m0, s24, 24576
    s_nop 0
    buffer_load_dwordx4 v111, s[8:11], s20 offen offset:0 lds
    buffer_load_dwordx4 v111, s[8:11], s21 offen offset:1024 lds
    buffer_load_dwordx4 v111, s[8:11], s22 offen offset:2048 lds
    s_add_u32 s68, s68, 1
    s_and_b32 s68, s68, 7
    s_cselect_b32 s33, s23, s69
    s_add_u32 s20, s20, s33
    s_add_u32 s21, s21, s33
    s_add_u32 s22, s22, s33
    s_mov_b32 s33, 0x3ea52b5c
    v_cmp_eq_u32 vcc, 0, v113
    s_waitcnt lgkmcnt(0)
    v_lshlrev_b32 v118, 16, v52
    v_and_b32 v119, 0xffff0000, v52
    v_mul_f32 v118, s33, v118
    v_mul_f32 v119, s33, v119
    v_cvt_pk_bf16_f32 v4, v118, v119
    v_lshlrev_b32 v118, 16, v53
    v_and_b32 v119, 0xffff0000, v53
    v_mul_f32 v118, s33, v118
    v_mul_f32 v119, s33, v119
    v_cvt_pk_bf16_f32 v5, v118, v119
    v_lshlrev_b32 v118, 16, v54
    v_and_b32 v119, 0xffff0000, v54
    v_mul_f32 v118, s33, v118
    v_mul_f32 v119, s33, v119
    v_cvt_pk_bf16_f32 v6, v118, v119
    v_lshlrev_b32 v118, 16, v55
    v_and_b32 v119, 0xffff0000, v55
    v_mul_f32 v118, s33, v118
    v_mul_f32 v119, s33, v119
    v_cvt_pk_bf16_f32 v7, v118, v119
    v_lshlrev_b32 v118, 16, v56
    v_and_b32 v119, 0xffff0000, v56
    v_mul_f32 v118, s33, v118
    v_mul_f32 v119, s33, v119
    v_cvt_pk_bf16_f32 v118, v118, v119
    v_cndmask_b32 v8, 0, v118, vcc
    v_cndmask_b32 v10, v118, 0, vcc
    v_lshlrev_b32 v118, 16, v57
    v_and_b32 v119, 0xffff0000, v57
    v_mul_f32 v118, s33, v118
    v_mul_f32 v119, s33, v119
    v_cvt_pk_bf16_f32 v118, v118, v119
    v_cndmask_b32 v9, 0, v118, vcc
    v_cndmask_b32 v11, v118, 0, vcc
    v_lshlrev_b32 v118, 16, v60
    v_and_b32 v119, 0xffff0000, v60
    v_mul_f32 v118, s33, v118
    v_mul_f32 v119, s33, v119
    v_cvt_pk_bf16_f32 v12, v118, v119
    v_lshlrev_b32 v118, 16, v61
    v_and_b32 v119, 0xffff0000, v61
    v_mul_f32 v118, s33, v118
    v_mul_f32 v119, s33, v119
    v_cvt_pk_bf16_f32 v13, v118, v119
    v_lshlrev_b32 v118, 16, v62
    v_and_b32 v119, 0xffff0000, v62
    v_mul_f32 v118, s33, v118
    v_mul_f32 v119, s33, v119
    v_cvt_pk_bf16_f32 v14, v118, v119
    v_lshlrev_b32 v118, 16, v63
    v_and_b32 v119, 0xffff0000, v63
    v_mul_f32 v118, s33, v118
    v_mul_f32 v119, s33, v119
    v_cvt_pk_bf16_f32 v15, v118, v119
    v_lshlrev_b32 v118, 16, v64
    v_and_b32 v119, 0xffff0000, v64
    v_mul_f32 v118, s33, v118
    v_mul_f32 v119, s33, v119
    v_cvt_pk_bf16_f32 v118, v118, v119
    v_cndmask_b32 v16, 0, v118, vcc
    v_cndmask_b32 v18, v118, 0, vcc
    v_lshlrev_b32 v118, 16, v65
    v_and_b32 v119, 0xffff0000, v65
    v_mul_f32 v118, s33, v118
    v_mul_f32 v119, s33, v119
    v_cvt_pk_bf16_f32 v118, v118, v119
    v_cndmask_b32 v17, 0, v118, vcc
    v_cndmask_b32 v19, v118, 0, vcc
    v_mov_b32 v120, 0
    v_mov_b32 v121, 0
    v_mov_b32 v122, 0
    v_mov_b32 v123, 0
    v_mov_b32 v124, 0
    v_mov_b32 v125, 0
    v_mov_b32 v126, 0
    v_mov_b32 v127, 0
    v_mov_b32 v0, 73732
    v_mov_b32 v1, 1
    s_mov_b32 s32, 8
    ds_read_b128 v[92:95], v108 offset:0
    ds_read_b64 v[96:97], v109 offset:0
    s_mov_b32 s26, 0
    s_mov_b32 s25, 49152
    s_mov_b32 s37, 0
    s_movk_i32 s39, 24576
    s_waitcnt lgkmcnt(0)
    v_mfma_f32_32x32x16_bf16 v[52:67], v[92:95], v[4:7], 0
    v_mfma_f32_32x32x8_bf16 v[52:67], v[96:97], v[8:9], v[52:67]
    s_setprio 3
    s_nop 7
    s_nop 3
.p2align 6
a_loop:
    v_exp_f32 v52, v52
    v_exp_f32 v53, v53
    v_mfma_f32_32x32x16_bf16 v[36:51], v[100:103], v[120:123], v[36:51]
    s_mov_b64 exec, s[18:19]
    ds_read_b128 v[100:103], v110 offset:0
    s_mov_b64 exec, -1
    v_exp_f32 v54, v54
    v_cvt_pk_bf16_f32 v84, v52, v53
    v_exp_f32 v55, v55
    v_exp_f32 v56, v56
    v_cvt_pk_bf16_f32 v85, v54, v55
    v_exp_f32 v57, v57
    v_mfma_f32_32x32x16_bf16 v[68:83], v[92:95], v[12:15], 0
    ds_read_b128 v[92:95], v108 offset:512
    v_exp_f32 v58, v58
    v_cvt_pk_bf16_f32 v86, v56, v57
    v_exp_f32 v59, v59
    v_exp_f32 v60, v60
    v_mfma_f32_32x32x8_bf16 v[68:83], v[96:97], v[16:17], v[68:83]
    v_cvt_pk_bf16_f32 v87, v58, v59
    v_exp_f32 v61, v61
    v_exp_f32 v62, v62
    v_cvt_pk_bf16_f32 v88, v60, v61
    v_exp_f32 v63, v63
    v_exp_f32 v64, v64
    v_cvt_pk_bf16_f32 v89, v62, v63
    v_exp_f32 v65, v65
    v_mfma_f32_32x32x16_bf16 v[36:51], v[104:107], v[124:127], v[36:51]
    s_mov_b64 exec, s[18:19]
    ds_read_b128 v[104:107], v110 offset:640
    s_mov_b64 exec, -1
    v_exp_f32 v66, v66
    v_exp_f32 v67, v67
    v_cvt_pk_bf16_f32 v90, v64, v65
    v_cvt_pk_bf16_f32 v91, v66, v67
    s_setprio 2
    v_exp_f32 v68, v68
    v_exp_f32 v69, v69
    s_waitcnt lgkmcnt(2)
    v_mfma_f32_32x32x16_bf16 v[20:35], v[100:103], v[84:87], v[20:35]
    v_exp_f32 v70, v70
    v_cvt_pk_bf16_f32 v120, v68, v69
    v_exp_f32 v71, v71
    v_exp_f32 v72, v72
    v_cvt_pk_bf16_f32 v121, v70, v71
    v_exp_f32 v73, v73
    s_waitcnt lgkmcnt(1)
    v_mfma_f32_32x32x16_bf16 v[52:67], v[92:95], v[4:7], 0
    v_exp_f32 v74, v74
    v_cvt_pk_bf16_f32 v122, v72, v73
    v_exp_f32 v75, v75
    v_exp_f32 v76, v76
    v_mfma_f32_32x32x8_bf16 v[52:67], v[96:97], v[10:11], v[52:67]
    v_cvt_pk_bf16_f32 v123, v74, v75
    v_exp_f32 v77, v77
    v_exp_f32 v78, v78
    v_cvt_pk_bf16_f32 v124, v76, v77
    v_exp_f32 v79, v79
    v_exp_f32 v80, v80
    v_cvt_pk_bf16_f32 v125, v78, v79
    v_exp_f32 v81, v81
    s_waitcnt lgkmcnt(0)
    v_mfma_f32_32x32x16_bf16 v[20:35], v[104:107], v[88:91], v[20:35]
    v_exp_f32 v82, v82
    v_exp_f32 v83, v83
    v_cvt_pk_bf16_f32 v126, v80, v81
    v_cvt_pk_bf16_f32 v127, v82, v83
    v_exp_f32 v52, v52
    v_exp_f32 v53, v53
    v_mfma_f32_32x32x16_bf16 v[36:51], v[100:103], v[120:123], v[36:51]
    s_mov_b64 exec, s[18:19]
    ds_read_b128 v[100:103], v110 offset:1280
    s_mov_b64 exec, -1
    v_exp_f32 v54, v54
    v_cvt_pk_bf16_f32 v84, v52, v53
    v_exp_f32 v55, v55
    v_exp_f32 v56, v56
    v_cvt_pk_bf16_f32 v85, v54, v55
    v_exp_f32 v57, v57
    v_mfma_f32_32x32x16_bf16 v[68:83], v[92:95], v[12:15], 0
    s_cmp_lg_u32 s38, 0
    s_cbranch_scc1 a_bi
a_nb1:
    ds_read_b128 v[92:95], v108 offset:1024
    v_exp_f32 v58, v58
    v_cvt_pk_bf16_f32 v86, v56, v57
    v_exp_f32 v59, v59
    v_exp_f32 v60, v60
    v_mfma_f32_32x32x8_bf16 v[68:83], v[96:97], v[18:19], v[68:83]
    ds_read_b64 v[96:97], v109 offset:1024
    v_cvt_pk_bf16_f32 v87, v58, v59
    v_exp_f32 v61, v61
    v_exp_f32 v62, v62
    v_cvt_pk_bf16_f32 v88, v60, v61
    v_exp_f32 v63, v63
    v_exp_f32 v64, v64
    v_cvt_pk_bf16_f32 v89, v62, v63
    v_exp_f32 v65, v65
    v_mfma_f32_32x32x16_bf16 v[36:51], v[104:107], v[124:127], v[36:51]
    s_mov_b64 exec, s[18:19]
    ds_read_b128 v[104:107], v110 offset:1920
    s_mov_b64 exec, -1
    v_exp_f32 v66, v66
    v_exp_f32 v67, v67
    v_cvt_pk_bf16_f32 v90, v64, v65
    v_cvt_pk_bf16_f32 v91, v66, v67
    s_setprio 1
    v_exp_f32 v68, v68
    v_exp_f32 v69, v69
    s_waitcnt lgkmcnt(3)
    v_mfma_f32_32x32x16_bf16 v[20:35], v[100:103], v[84:87], v[20:35]
    v_exp_f32 v70, v70
    v_cvt_pk_bf16_f32 v120, v68, v69
    v_exp_f32 v71, v71
    v_exp_f32 v72, v72
    v_cvt_pk_bf16_f32 v121, v70, v71
    v_exp_f32 v73, v73
    s_waitcnt lgkmcnt(2)
    v_mfma_f32_32x32x16_bf16 v[52:67], v[92:95], v[4:7], 0
    v_exp_f32 v74, v74
    v_cvt_pk_bf16_f32 v122, v72, v73
    v_exp_f32 v75, v75
    v_exp_f32 v76, v76
    s_waitcnt lgkmcnt(1)
    v_mfma_f32_32x32x8_bf16 v[52:67], v[96:97], v[8:9], v[52:67]
    v_cvt_pk_bf16_f32 v123, v74, v75
    v_exp_f32 v77, v77
    v_exp_f32 v78, v78
    v_cvt_pk_bf16_f32 v124, v76, v77
    v_exp_f32 v79, v79
    v_exp_f32 v80, v80
    v_cvt_pk_bf16_f32 v125, v78, v79
    v_exp_f32 v81, v81
    s_waitcnt lgkmcnt(0)
    v_mfma_f32_32x32x16_bf16 v[20:35], v[104:107], v[88:91], v[20:35]
    v_exp_f32 v82, v82
    v_exp_f32 v83, v83
    v_cvt_pk_bf16_f32 v126, v80, v81
    v_cvt_pk_bf16_f32 v127, v82, v83
    v_exp_f32 v52, v52
    v_exp_f32 v53, v53
    v_mfma_f32_32x32x16_bf16 v[36:51], v[100:103], v[120:123], v[36:51]
    s_mov_b64 exec, s[18:19]
    ds_read_b128 v[100:103], v110 offset:2560
    s_mov_b64 exec, -1
    v_exp_f32 v54, v54
    v_cvt_pk_bf16_f32 v84, v52, v53
    v_exp_f32 v55, v55
    s_cmp_eq_u32 s26, 7
    s_cbranch_scc1 a_nw
    s_waitcnt vmcnt(0)
a_nw:
    s_cmp_eq_u32 s38, 0
    s_cbranch_scc0 a_bchk
a_bok:
    s_mov_b64 exec, 1
    ds_add_u32 v0, v1
    s_mov_b64 exec, -1
    v_exp_f32 v56, v56
    v_cvt_pk_bf16_f32 v85, v54, v55
    v_exp_f32 v57, v57
    v_mfma_f32_32x32x16_bf16 v[68:83], v[92:95], v[12:15], 0
    ds_read_b128 v[92:95], v108 offset:1536
    v_exp_f32 v58, v58
    v_cvt_pk_bf16_f32 v86, v56, v57
    v_exp_f32 v59, v59
    v_exp_f32 v60, v60
    v_mfma_f32_32x32x8_bf16 v[68:83], v[96:97], v[16:17], v[68:83]
    v_cvt_pk_bf16_f32 v87, v58, v59
    v_exp_f32 v61, v61
    v_exp_f32 v62, v62
    v_cvt_pk_bf16_f32 v88, v60, v61
    v_exp_f32 v63, v63
    v_exp_f32 v64, v64
    v_cvt_pk_bf16_f32 v89, v62, v63
    v_exp_f32 v65, v65
    v_mfma_f32_32x32x16_bf16 v[36:51], v[104:107], v[124:127], v[36:51]
    s_mov_b64 exec, s[18:19]
    ds_read_b128 v[104:107], v110 offset:3200
    s_mov_b64 exec, -1
    v_exp_f32 v66, v66
    v_exp_f32 v67, v67
    v_cvt_pk_bf16_f32 v90, v64, v65
    v_cvt_pk_bf16_f32 v91, v66, v67
    s_setprio 0
    v_exp_f32 v68, v68
    v_exp_f32 v69, v69
    s_waitcnt lgkmcnt(3)
    v_mfma_f32_32x32x16_bf16 v[20:35], v[100:103], v[84:87], v[20:35]
    v_exp_f32 v70, v70
    v_cvt_pk_bf16_f32 v120, v68, v69
    v_exp_f32 v71, v71
    v_exp_f32 v72, v72
    v_cvt_pk_bf16_f32 v121, v70, v71
    v_exp_f32 v73, v73
    s_waitcnt lgkmcnt(1)
    v_mfma_f32_32x32x16_bf16 v[52:67], v[92:95], v[4:7], 0
    v_exp_f32 v74, v74
    v_cvt_pk_bf16_f32 v122, v72, v73
    v_exp_f32 v75, v75
    v_exp_f32 v76, v76
    v_mfma_f32_32x32x8_bf16 v[52:67], v[96:97], v[10:11], v[52:67]
    v_cvt_pk_bf16_f32 v123, v74, v75
    v_exp_f32 v77, v77
    v_exp_f32 v78, v78
    v_cvt_pk_bf16_f32 v124, v76, v77
    v_exp_f32 v79, v79
    v_exp_f32 v80, v80
    v_cvt_pk_bf16_f32 v125, v78, v79
    v_exp_f32 v81, v81
    s_waitcnt lgkmcnt(0)
    v_mfma_f32_32x32x16_bf16 v[20:35], v[104:107], v[88:91], v[20:35]
    v_exp_f32 v82, v82
    v_exp_f32 v83, v83
    ds_read_b32 v3, v0
    v_cvt_pk_bf16_f32 v126, v80, v81
    v_cvt_pk_bf16_f32 v127, v82, v83
    v_exp_f32 v52, v52
    v_exp_f32 v53, v53
    v_mfma_f32_32x32x16_bf16 v[36:51], v[100:103], v[120:123], v[36:51]
    s_mov_b64 exec, s[18:19]
    ds_read_b128 v[100:103], v110 offset:3840
    s_mov_b64 exec, -1
    v_exp_f32 v54, v54
    v_cvt_pk_bf16_f32 v84, v52, v53
    v_exp_f32 v55, v55
    v_exp_f32 v56, v56
    v_cvt_pk_bf16_f32 v85, v54, v55
    v_exp_f32 v57, v57
    v_mfma_f32_32x32x16_bf16 v[68:83], v[92:95], v[12:15], 0
    s_waitcnt lgkmcnt(1)
    v_readfirstlane_b32 s33, v3
    s_cmp_eq_u32 s37, 49152
    s_cselect_b32 s27, 0xffff4000, s39
    s_add_u32 s37, s37, s27
    v_add_u32 v108, s27, v108
    v_add_u32 v109, s27, v109
    s_cmp_lt_u32 s33, s32
    s_cbranch_scc1 a_sw
a_swd:
    s_add_u32 s32, s32, 8
    ds_read_b128 v[92:95], v108 offset:0
    v_exp_f32 v58, v58
    v_cvt_pk_bf16_f32 v86, v56, v57
    v_exp_f32 v59, v59
    v_exp_f32 v60, v60
    v_mfma_f32_32x32x8_bf16 v[68:83], v[96:97], v[18:19], v[68:83]
    ds_read_b64 v[96:97], v109 offset:0
    v_cvt_pk_bf16_f32 v87, v58, v59
    v_exp_f32 v61, v61
    v_exp_f32 v62, v62
    v_cvt_pk_bf16_f32 v88, v60, v61
    v_exp_f32 v63, v63
    v_exp_f32 v64, v64
    v_cvt_pk_bf16_f32 v89, v62, v63
    v_exp_f32 v65, v65
    v_mfma_f32_32x32x16_bf16 v[36:51], v[104:107], v[124:127], v[36:51]
    s_mov_b64 exec, s[18:19]
    ds_read_b128 v[104:107], v110 offset:4480
    s_mov_b64 exec, -1
    v_exp_f32 v66, v66
    s_cmp_ge_u32 s26, 6
    s_cbranch_scc1 a_nodma
    s_add_u32 m0, s24, s25
    s_nop 0
    buffer_load_dwordx4 v111, s[8:11], s20 offen offset:0 lds
    buffer_load_dwordx4 v111, s[8:11], s21 offen offset:1024 lds
    buffer_load_dwordx4 v111, s[8:11], s22 offen offset:2048 lds
    s_add_u32 s68, s68, 1
    s_and_b32 s68, s68, 7
    s_cselect_b32 s33, s23, s69
    s_add_u32 s20, s20, s33
    s_add_u32 s21, s21, s33
    s_add_u32 s22, s22, s33
    s_cmp_eq_u32 s25, 49152
    s_cselect_b32 s33, 0xffff4000, s39
    s_add_u32 s25, s25, s33
a_nodma2:
    v_exp_f32 v67, v67
    v_cvt_pk_bf16_f32 v90, v64, v65
    v_cvt_pk_bf16_f32 v91, v66, v67
    v_add_u32 v110, s27, v110
    s_setprio 3
    v_exp_f32 v68, v68
    v_exp_f32 v69, v69
    s_waitcnt lgkmcnt(3)
    v_mfma_f32_32x32x16_bf16 v[20:35], v[100:103], v[84:87], v[20:35]
    v_exp_f32 v70, v70
    v_cvt_pk_bf16_f32 v120, v68, v69
    v_exp_f32 v71, v71
    v_exp_f32 v72, v72
    v_cvt_pk_bf16_f32 v121, v70, v71
    v_exp_f32 v73, v73
    s_waitcnt lgkmcnt(2)
    v_mfma_f32_32x32x16_bf16 v[52:67], v[92:95], v[4:7], 0
    v_exp_f32 v74, v74
    v_cvt_pk_bf16_f32 v122, v72, v73
    v_exp_f32 v75, v75
    v_exp_f32 v76, v76
    s_waitcnt lgkmcnt(1)
    v_mfma_f32_32x32x8_bf16 v[52:67], v[96:97], v[8:9], v[52:67]
    v_cvt_pk_bf16_f32 v123, v74, v75
    v_exp_f32 v77, v77
    v_exp_f32 v78, v78
    v_cvt_pk_bf16_f32 v124, v76, v77
    v_exp_f32 v79, v79
    v_exp_f32 v80, v80
    v_cvt_pk_bf16_f32 v125, v78, v79
    v_exp_f32 v81, v81
    s_waitcnt lgkmcnt(0)
    v_mfma_f32_32x32x16_bf16 v[20:35], v[104:107], v[88:91], v[20:35]
    v_exp_f32 v82, v82
    v_exp_f32 v83, v83
    v_cvt_pk_bf16_f32 v126, v80, v81
    v_cvt_pk_bf16_f32 v127, v82, v83
    s_add_u32 s26, s26, 1
    s_cmp_lt_u32 s26, 8
    s_cbranch_scc1 a_loop
    v_mfma_f32_32x32x16_bf16 v[36:51], v[100:103], v[120:123], v[36:51]
    v_mfma_f32_32x32x16_bf16 v[36:51], v[104:107], v[124:127], v[36:51]
    s_setprio 3
    s_add_u32 s33, s24, 24576
    s_xor_b32 s34, s14, 4
    s_mul_i32 s34, s34, 3072
    s_add_u32 s34, s34, 24576
    v_add_u32 v120, s33, v111
    v_add_u32 v121, s34, v111
    s_mul_i32 s33, s16, 512
    v_add_u32 v114, s33, v114
    v_add_u32 v115, s33, v115
    s_mul_i32 s34, s31, 32768
    s_add_u32 s34, s34, 7864320
    s_add_u32 s35, s35, 7864320
    s_waitcnt lgkmcnt(0)
    s_barrier
    s_cmp_eq_u32 s16, 0
    s_cbranch_scc1 a_k0
    ds_write_b128 v120, v[20:23] offset:0
    ds_write_b128 v120, v[24:27] offset:1024
    ds_write_b128 v120, v[28:31] offset:2048
    s_waitcnt lgkmcnt(0)
    s_barrier
    ds_read_b128 v[76:79], v121 offset:2048
    ds_read_b128 v[68:71], v121 offset:0
    ds_read_b128 v[72:75], v121 offset:1024
    s_waitcnt lgkmcnt(2)
    v_add_f32 v76, v76, v44
    v_add_f32 v77, v77, v45
    v_add_f32 v78, v78, v46
    v_add_f32 v79, v79, v47
    s_waitcnt lgkmcnt(1)
    v_add_f32 v68, v68, v36
    v_add_f32 v69, v69, v37
    v_add_f32 v70, v70, v38
    v_add_f32 v71, v71, v39
    s_waitcnt lgkmcnt(0)
    v_add_f32 v72, v72, v40
    v_add_f32 v73, v73, v41
    v_add_f32 v74, v74, v42
    v_add_f32 v75, v75, v43
    s_branch a_fin
a_k0:
    ds_write_b128 v120, v[36:39] offset:0
    ds_write_b128 v120, v[40:43] offset:1024
    ds_write_b128 v120, v[44:47] offset:2048
    s_waitcnt lgkmcnt(0)
    s_barrier
    ds_read_b128 v[76:79], v121 offset:2048
    ds_read_b128 v[68:71], v121 offset:0
    ds_read_b128 v[72:75], v121 offset:1024
    s_waitcnt lgkmcnt(2)
    v_add_f32 v76, v76, v28
    v_add_f32 v77, v77, v29
    v_add_f32 v78, v78, v30
    v_add_f32 v79, v79, v31
    s_waitcnt lgkmcnt(1)
    v_add_f32 v68, v68, v20
    v_add_f32 v69, v69, v21
    v_add_f32 v70, v70, v22
    v_add_f32 v71, v71, v23
    s_waitcnt lgkmcnt(0)
    v_add_f32 v72, v72, v24
    v_add_f32 v73, v73, v25
    v_add_f32 v74, v74, v26
    v_add_f32 v75, v75, v27
a_fin:
    v_mov_b32 v122, v76
    v_mov_b32 v123, v76
    v_max3_f32 v124, |v68|, |v69|, |v70|
    v_max3_f32 v125, |v71|, |v72|, |v73|
    v_permlane32_swap_b32 v122, v123
    v_max3_f32 v126, |v74|, |v75|, |v76|
    v_max3_f32 v127, |v77|, |v78|, |v79|
    v_rcp_f32 v122, v123
    v_max3_f32 v124, v124, v125, v126
    v_max_f32 v124, v124, v127
    s_mov_b32 s33, 0x1f800000
    s_mov_b32 s36, 0x5f800000
    s_mov_b32 s38, 0x7f000000
    v_cmp_le_f32 s[40:41], s33, v123
    v_cmp_ge_f32 s[42:43], s36, v123
    v_cmp_ge_f32 vcc, s38, v124
    v_mul_f32 v68, v68, v122
    v_mul_f32 v69, v69, v122
    v_mul_f32 v70, v70, v122
    v_mul_f32 v71, v71, v122
    v_mul_f32 v72, v72, v122
    v_mul_f32 v73, v73, v122
    v_mul_f32 v74, v74, v122
    v_mul_f32 v75, v75, v122
    v_mul_f32 v76, v76, v122
    v_mul_f32 v77, v77, v122
    v_mul_f32 v78, v78, v122
    v_mul_f32 v79, v79, v122
    s_and_b64 s[40:41], s[40:41], s[42:43]
    s_and_b64 s[40:41], s[40:41], vcc
    s_cmp_eq_u64 s[40:41], -1
    s_cbranch_scc1 a_ok
    s_cmp_eq_u32 s26, 99
    s_cbranch_scc0 a_slow
a_ok:
    v_cvt_pk_bf16_f32 v52, v68, v69
    v_cvt_pk_bf16_f32 v53, v70, v71
    v_cvt_pk_bf16_f32 v54, v72, v73
    v_cvt_pk_bf16_f32 v55, v74, v75
    v_cvt_pk_bf16_f32 v56, v76, v77
    v_cvt_pk_bf16_f32 v57, v78, v79
    buffer_store_dwordx4 v[52:55], v115, s[8:11], s34 offen sc1
    s_mov_b32 exec_hi, 0
    buffer_store_dwordx2 v[56:57], v114, s[8:11], s35 offen sc1
    s_mov_b64 exec, -1
    s_lshl_b32 s33, s13, 3
    s_lshl_b32 s34, s15, 1
    s_add_u32 s33, s33, s34
    s_add_u32 s33, s33, s16
    s_lshl_b32 s33, s33, 5
    s_add_u32 s33, s33, s12
    s_lshl_b32 s33, s33, 6
    s_add_u32 s30, s33, 12582912
    v_mul_u32_u24 v0, 131328, v2
    v_mov_b32 v1, s80
    s_cmp_ge_u32 s71, 12
    s_cbranch_scc1 o_go
    s_waitcnt vmcnt(0)
    s_mov_b64 exec, 1
    buffer_store_dword v1, v0, s[8:11], s30 offen sc1
    s_mov_b64 exec, -1
    s_endpgm
o_go:
    s_sub_u32 s31, s71, 12
    s_and_b32 s17, s31, 1
    s_lshr_b32 s18, s31, 1
    s_lshl_b32 s33, s70, 1
    s_add_u32 s17, s17, s33
    s_barrier
    s_mul_i32 s33, s14, 30720
    s_add_u32 s33, s33, s73
    s_add_u32 m0, s24, 24576
    s_add_u32 s81, s33, 245760
    buffer_load_dwordx4 v98, s[76:79], s81 offen lds
    s_add_u32 m0, s24, 25600
    s_add_u32 s81, s33, 256000
    buffer_load_dwordx4 v99, s[76:79], s81 offen lds
    s_add_u32 m0, s24, 26624
    s_add_u32 s81, s33, 266240
    buffer_load_dwordx4 v98, s[76:79], s81 offen lds
    s_lshl_b32 s33, s14, 10
    s_add_u32 m0, s33, 73728
    s_mul_i32 s33, s14, 10240
    s_add_u32 s33, s33, s73
    s_add_u32 s33, s33, 737280
    buffer_load_dwordx4 v98, s[76:79], s33 offen lds
    v_lshrrev_b32 v8, 4, v2
    v_bfe_u32 v9, v2, 2, 2
    v_lshl_add_u32 v10, v8, 3, v9
    v_lshlrev_b32 v10, 7, v10
    v_and_b32 v11, 3, v2
    v_lshl_add_u32 v10, v11, 3, v10
    v_and_b32 v9, 2, v9
    v_and_b32 v11, 1, v8
    v_or_b32 v9, v9, v11
    v_lshl_add_u32 v116, v9, 5, v10
    v_xor_b32 v117, 32, v116
    v_xor_b32 v118, 64, v116
    v_xor_b32 v119, 96, v116
    v_add_u32 v120, 0x8000, v116
    v_add_u32 v121, 0x8000, v117
    v_add_u32 v122, 0x8000, v118
    v_add_u32 v123, 0x8000, v119
    v_and_b32 v9, 15, v2
    v_mul_u32_u24 v124, 32768, v8
    v_lshl_add_u32 v124, v9, 4, v124
    s_mul_i32 s33, s17, 80
    s_add_u32 s33, s33, 768
    s_mul_i32 s34, s17, 48
    s_sub_u32 s34, s34, 80
    s_cmp_lt_u32 s14, 5
    s_cselect_b32 s33, s33, s34
    s_lshl_b32 s34, s14, 4
    s_add_u32 s33, s33, s34
    v_add_u32 v9, s33, v9
    v_mul_u32_u24 v126, 5120, v9
    v_lshl_add_u32 v126, v8, 4, v126
    s_mul_i32 s22, s33, 16
    s_add_u32 s22, s22, 7864320
    s_lshr_b32 s33, s33, 5
    s_lshl_b32 s33, s33, 11
    s_and_b32 s34, s18, 0
    s_mul_i32 s34, s34, 131328
    s_add_u32 s33, s33, s34
    s_add_u32 s25, s33, 12582912
    v_and_b32 v3, 31, v2
    v_lshlrev_b32 v3, 6, v3
    buffer_load_dword v125, v3, s[8:11], s25 offen sc1
    s_mov_b32 s26, 0x01010101
    s_mov_b32 s27, 0
    s_mov_b32 s37, 0
    s_mov_b32 s36, 0
    s_mov_b32 s35, 0
    v_mov_b32 v84, 0
    v_mov_b32 v85, 0
    v_mov_b32 v86, 0
    v_mov_b32 v87, 0
    v_mov_b32 v88, 0
    v_mov_b32 v89, 0
    v_mov_b32 v90, 0
    v_mov_b32 v91, 0
    v_mov_b32 v92, 0
    v_mov_b32 v93, 0
    v_mov_b32 v94, 0
    v_mov_b32 v95, 0
    v_mov_b32 v96, 0
    v_mov_b32 v97, 0
    v_mov_b32 v98, 0
    v_mov_b32 v99, 0
    s_waitcnt vmcnt(5)
    s_mov_b64 exec, 1
    buffer_store_dword v1, v0, s[8:11], s30 offen sc1
    s_mov_b64 exec, -1
    s_waitcnt vmcnt(2)
    s_barrier
    s_waitcnt vmcnt(1)
    s_branch o_eval
o_loop:
    s_mov_b32 s35, s27
    s_cmp_eq_u32 s26, 0
    s_cselect_b32 s36, 1, 0
    s_cbranch_scc1 o_cmp
    s_waitcnt vmcnt(0)
o_eval:
    v_cmp_ne_u32 vcc, s80, v125
    s_add_u32 s37, s37, 1
    s_lshr_b32 s33, vcc_lo, 1
    s_or_b32 s33, s33, vcc_lo
    s_lshr_b32 s34, s33, 2
    s_or_b32 s33, s33, s34
    s_lshr_b32 s34, s33, 4
    s_or_b32 s33, s33, s34
    s_cmp_gt_u32 s37, 200000
    s_cselect_b32 s33, 0, s33
    s_andn2_b32 s27, s26, s33
    s_andn2_b32 s26, s26, s27
    s_or_b32 s33, s27, s35
    s_cbranch_scc1 o_ns
    s_sleep 3
o_ns:
    s_bitcmp1_b32 s27, 0
    s_cbranch_scc0 o_i0
    s_add_u32 s23, s22, 0
    buffer_load_dwordx4 v[4:7], v124, s[8:11], s23 offen
    s_add_u32 s23, s22, 131072
    buffer_load_dwordx4 v[8:11], v124, s[8:11], s23 offen
    s_add_u32 s23, s22, 262144
    buffer_load_dwordx4 v[12:15], v124, s[8:11], s23 offen
    s_add_u32 s23, s22, 393216
    buffer_load_dwordx4 v[16:19], v124, s[8:11], s23 offen
    s_add_u32 s23, s22, 524288
    buffer_load_dwordx4 v[20:23], v124, s[8:11], s23 offen
o_i0:
    s_bitcmp1_b32 s27, 8
    s_cbranch_scc0 o_i1
    s_add_u32 s23, s22, 655360
    buffer_load_dwordx4 v[24:27], v124, s[8:11], s23 offen
    s_add_u32 s23, s22, 786432
    buffer_load_dwordx4 v[28:31], v124, s[8:11], s23 offen
    s_add_u32 s23, s22, 917504
    buffer_load_dwordx4 v[32:35], v124, s[8:11], s23 offen
    s_add_u32 s23, s22, 1048576
    buffer_load_dwordx4 v[36:39], v124, s[8:11], s23 offen
    s_add_u32 s23, s22, 1179648
    buffer_load_dwordx4 v[40:43], v124, s[8:11], s23 offen
o_i1:
    s_bitcmp1_b32 s27, 16
    s_cbranch_scc0 o_i2
    s_add_u32 s23, s22, 1310720
    buffer_load_dwordx4 v[44:47], v124, s[8:11], s23 offen
    s_add_u32 s23, s22, 1441792
    buffer_load_dwordx4 v[48:51], v124, s[8:11], s23 offen
    s_add_u32 s23, s22, 1572864
    buffer_load_dwordx4 v[52:55], v124, s[8:11], s23 offen
    s_add_u32 s23, s22, 1703936
    buffer_load_dwordx4 v[56:59], v124, s[8:11], s23 offen
    s_add_u32 s23, s22, 1835008
    buffer_load_dwordx4 v[60:63], v124, s[8:11], s23 offen
o_i2:
    s_bitcmp1_b32 s27, 24
    s_cbranch_scc0 o_i3
    s_add_u32 s23, s22, 1966080
    buffer_load_dwordx4 v[64:67], v124, s[8:11], s23 offen
    s_add_u32 s23, s22, 2097152
    buffer_load_dwordx4 v[68:71], v124, s[8:11], s23 offen
    s_add_u32 s23, s22, 2228224
    buffer_load_dwordx4 v[72:75], v124, s[8:11], s23 offen
    s_add_u32 s23, s22, 2359296
    buffer_load_dwordx4 v[76:79], v124, s[8:11], s23 offen
    s_add_u32 s23, s22, 2490368
    buffer_load_dwordx4 v[80:83], v124, s[8:11], s23 offen
o_i3:
    s_cmp_eq_u32 s26, 0
    s_cbranch_scc1 o_np
    buffer_load_dword v125, v3, s[8:11], s25 offen sc1
o_np:
o_cmp:
    s_bitcmp1_b32 s35, 0
    s_cbranch_scc0 o_c0
    ds_read_b64_tr_b16 v[100:101], v116 offset:0
    ds_read_b64_tr_b16 v[102:103], v116 offset:512
    ds_read_b64_tr_b16 v[104:105], v117 offset:0
    ds_read_b64_tr_b16 v[106:107], v117 offset:512
    ds_read_b64_tr_b16 v[108:109], v118 offset:0
    ds_read_b64_tr_b16 v[110:111], v118 offset:512
    ds_read_b64_tr_b16 v[112:113], v119 offset:0
    ds_read_b64_tr_b16 v[114:115], v119 offset:512
    s_cmp_eq_u32 s36, 0
    s_cbranch_scc1 o_c0w
    s_lshr_b32 s33, s35, 8
    s_bcnt1_i32_b32 s33, s33
    s_waitcnt vmcnt(15)
    s_cmp_eq_u32 s33, 3
    s_cbranch_scc1 o_c0w
    s_waitcnt vmcnt(10)
    s_cmp_eq_u32 s33, 2
    s_cbranch_scc1 o_c0w
    s_waitcnt vmcnt(5)
    s_cmp_eq_u32 s33, 1
    s_cbranch_scc1 o_c0w
    s_waitcnt vmcnt(0)
o_c0w:
    s_waitcnt lgkmcnt(6)
    v_mfma_f32_16x16x32_bf16 v[84:87], v[100:103], v[4:7], v[84:87]
    ds_read_b64_tr_b16 v[100:101], v116 offset:4096
    ds_read_b64_tr_b16 v[102:103], v116 offset:4608
    s_waitcnt lgkmcnt(6)
    v_mfma_f32_16x16x32_bf16 v[88:91], v[104:107], v[4:7], v[88:91]
    ds_read_b64_tr_b16 v[104:105], v117 offset:4096
    ds_read_b64_tr_b16 v[106:107], v117 offset:4608
    s_waitcnt lgkmcnt(6)
    v_mfma_f32_16x16x32_bf16 v[92:95], v[108:111], v[4:7], v[92:95]
    ds_read_b64_tr_b16 v[108:109], v118 offset:4096
    ds_read_b64_tr_b16 v[110:111], v118 offset:4608
    s_waitcnt lgkmcnt(6)
    v_mfma_f32_16x16x32_bf16 v[96:99], v[112:115], v[4:7], v[96:99]
    ds_read_b64_tr_b16 v[112:113], v119 offset:4096
    ds_read_b64_tr_b16 v[114:115], v119 offset:4608
    s_waitcnt lgkmcnt(6)
    v_mfma_f32_16x16x32_bf16 v[84:87], v[100:103], v[8:11], v[84:87]
    ds_read_b64_tr_b16 v[100:101], v116 offset:8192
    ds_read_b64_tr_b16 v[102:103], v116 offset:8704
    s_waitcnt lgkmcnt(6)
    v_mfma_f32_16x16x32_bf16 v[88:91], v[104:107], v[8:11], v[88:91]
    ds_read_b64_tr_b16 v[104:105], v117 offset:8192
    ds_read_b64_tr_b16 v[106:107], v117 offset:8704
    s_waitcnt lgkmcnt(6)
    v_mfma_f32_16x16x32_bf16 v[92:95], v[108:111], v[8:11], v[92:95]
    ds_read_b64_tr_b16 v[108:109], v118 offset:8192
    ds_read_b64_tr_b16 v[110:111], v118 offset:8704
    s_waitcnt lgkmcnt(6)
    v_mfma_f32_16x16x32_bf16 v[96:99], v[112:115], v[8:11], v[96:99]
    ds_read_b64_tr_b16 v[112:113], v119 offset:8192
    ds_read_b64_tr_b16 v[114:115], v119 offset:8704
    s_waitcnt lgkmcnt(6)
    v_mfma_f32_16x16x32_bf16 v[84:87], v[100:103], v[12:15], v[84:87]
    ds_read_b64_tr_b16 v[100:101], v116 offset:12288
    ds_read_b64_tr_b16 v[102:103], v116 offset:12800
    s_waitcnt lgkmcnt(6)
    v_mfma_f32_16x16x32_bf16 v[88:91], v[104:107], v[12:15], v[88:91]
    ds_read_b64_tr_b16 v[104:105], v117 offset:12288
    ds_read_b64_tr_b16 v[106:107], v117 offset:12800
    s_waitcnt lgkmcnt(6)
    v_mfma_f32_16x16x32_bf16 v[92:95], v[108:111], v[12:15], v[92:95]
    ds_read_b64_tr_b16 v[108:109], v118 offset:12288
    ds_read_b64_tr_b16 v[110:111], v118 offset:12800
    s_waitcnt lgkmcnt(6)
    v_mfma_f32_16x16x32_bf16 v[96:99], v[112:115], v[12:15], v[96:99]
    ds_read_b64_tr_b16 v[112:113], v119 offset:12288
    ds_read_b64_tr_b16 v[114:115], v119 offset:12800
    s_waitcnt lgkmcnt(6)
    v_mfma_f32_16x16x32_bf16 v[84:87], v[100:103], v[16:19], v[84:87]
    ds_read_b64_tr_b16 v[100:101], v116 offset:16384
    ds_read_b64_tr_b16 v[102:103], v116 offset:16896
    s_waitcnt lgkmcnt(6)
    v_mfma_f32_16x16x32_bf16 v[88:91], v[104:107], v[16:19], v[88:91]
    ds_read_b64_tr_b16 v[104:105], v117 offset:16384
    ds_read_b64_tr_b16 v[106:107], v117 offset:16896
    s_waitcnt lgkmcnt(6)
    v_mfma_f32_16x16x32_bf16 v[92:95], v[108:111], v[16:19], v[92:95]
    ds_read_b64_tr_b16 v[108:109], v118 offset:16384
    ds_read_b64_tr_b16 v[110:111], v118 offset:16896
    s_waitcnt lgkmcnt(6)
    v_mfma_f32_16x16x32_bf16 v[96:99], v[112:115], v[16:19], v[96:99]
    ds_read_b64_tr_b16 v[112:113], v119 offset:16384
    ds_read_b64_tr_b16 v[114:115], v119 offset:16896
    s_waitcnt lgkmcnt(6)
    v_mfma_f32_16x16x32_bf16 v[84:87], v[100:103], v[20:23], v[84:87]
    s_waitcnt lgkmcnt(4)
    v_mfma_f32_16x16x32_bf16 v[88:91], v[104:107], v[20:23], v[88:91]
    s_waitcnt lgkmcnt(2)
    v_mfma_f32_16x16x32_bf16 v[92:95], v[108:111], v[20:23], v[92:95]
    s_waitcnt lgkmcnt(0)
    v_mfma_f32_16x16x32_bf16 v[96:99], v[112:115], v[20:23], v[96:99]
o_c0:
    s_bitcmp1_b32 s35, 8
    s_cbranch_scc0 o_c1
    ds_read_b64_tr_b16 v[100:101], v116 offset:20480
    ds_read_b64_tr_b16 v[102:103], v116 offset:20992
    ds_read_b64_tr_b16 v[104:105], v117 offset:20480
    ds_read_b64_tr_b16 v[106:107], v117 offset:20992
    ds_read_b64_tr_b16 v[108:109], v118 offset:20480
    ds_read_b64_tr_b16 v[110:111], v118 offset:20992
    ds_read_b64_tr_b16 v[112:113], v119 offset:20480
    ds_read_b64_tr_b16 v[114:115], v119 offset:20992
    s_cmp_eq_u32 s36, 0
    s_cbranch_scc1 o_c1w
    s_lshr_b32 s33, s35, 16
    s_bcnt1_i32_b32 s33, s33
    s_waitcnt vmcnt(10)
    s_cmp_eq_u32 s33, 2
    s_cbranch_scc1 o_c1w
    s_waitcnt vmcnt(5)
    s_cmp_eq_u32 s33, 1
    s_cbranch_scc1 o_c1w
    s_waitcnt vmcnt(0)
o_c1w:
    s_waitcnt lgkmcnt(6)
    v_mfma_f32_16x16x32_bf16 v[84:87], v[100:103], v[24:27], v[84:87]
    ds_read_b64_tr_b16 v[100:101], v116 offset:24576
    ds_read_b64_tr_b16 v[102:103], v116 offset:25088
    s_waitcnt lgkmcnt(6)
    v_mfma_f32_16x16x32_bf16 v[88:91], v[104:107], v[24:27], v[88:91]
    ds_read_b64_tr_b16 v[104:105], v117 offset:24576
    ds_read_b64_tr_b16 v[106:107], v117 offset:25088
    s_waitcnt lgkmcnt(6)
    v_mfma_f32_16x16x32_bf16 v[92:95], v[108:111], v[24:27], v[92:95]
    ds_read_b64_tr_b16 v[108:109], v118 offset:24576
    ds_read_b64_tr_b16 v[110:111], v118 offset:25088
    s_waitcnt lgkmcnt(6)
    v_mfma_f32_16x16x32_bf16 v[96:99], v[112:115], v[24:27], v[96:99]
    ds_read_b64_tr_b16 v[112:113], v119 offset:24576
    ds_read_b64_tr_b16 v[114:115], v119 offset:25088
    s_waitcnt lgkmcnt(6)
    v_mfma_f32_16x16x32_bf16 v[84:87], v[100:103], v[28:31], v[84:87]
    ds_read_b64_tr_b16 v[100:101], v116 offset:28672
    ds_read_b64_tr_b16 v[102:103], v116 offset:29184
    s_waitcnt lgkmcnt(6)
    v_mfma_f32_16x16x32_bf16 v[88:91], v[104:107], v[28:31], v[88:91]
    ds_read_b64_tr_b16 v[104:105], v117 offset:28672
    ds_read_b64_tr_b16 v[106:107], v117 offset:29184
    s_waitcnt lgkmcnt(6)
    v_mfma_f32_16x16x32_bf16 v[92:95], v[108:111], v[28:31], v[92:95]
    ds_read_b64_tr_b16 v[108:109], v118 offset:28672
    ds_read_b64_tr_b16 v[110:111], v118 offset:29184
    s_waitcnt lgkmcnt(6)
    v_mfma_f32_16x16x32_bf16 v[96:99], v[112:115], v[28:31], v[96:99]
    ds_read_b64_tr_b16 v[112:113], v119 offset:28672
    ds_read_b64_tr_b16 v[114:115], v119 offset:29184
    s_waitcnt lgkmcnt(6)
    v_mfma_f32_16x16x32_bf16 v[84:87], v[100:103], v[32:35], v[84:87]
    ds_read_b64_tr_b16 v[100:101], v116 offset:32768
    ds_read_b64_tr_b16 v[102:103], v116 offset:33280
    s_waitcnt lgkmcnt(6)
    v_mfma_f32_16x16x32_bf16 v[88:91], v[104:107], v[32:35], v[88:91]
    ds_read_b64_tr_b16 v[104:105], v117 offset:32768
    ds_read_b64_tr_b16 v[106:107], v117 offset:33280
    s_waitcnt lgkmcnt(6)
    v_mfma_f32_16x16x32_bf16 v[92:95], v[108:111], v[32:35], v[92:95]
    ds_read_b64_tr_b16 v[108:109], v118 offset:32768
    ds_read_b64_tr_b16 v[110:111], v118 offset:33280
    s_waitcnt lgkmcnt(6)
    v_mfma_f32_16x16x32_bf16 v[96:99], v[112:115], v[32:35], v[96:99]
    ds_read_b64_tr_b16 v[112:113], v119 offset:32768
    ds_read_b64_tr_b16 v[114:115], v119 offset:33280
    s_waitcnt lgkmcnt(6)
    v_mfma_f32_16x16x32_bf16 v[84:87], v[100:103], v[36:39], v[84:87]
    ds_read_b64_tr_b16 v[100:101], v116 offset:36864
    ds_read_b64_tr_b16 v[102:103], v116 offset:37376
    s_waitcnt lgkmcnt(6)
    v_mfma_f32_16x16x32_bf16 v[88:91], v[104:107], v[36:39], v[88:91]
    ds_read_b64_tr_b16 v[104:105], v117 offset:36864
    ds_read_b64_tr_b16 v[106:107], v117 offset:37376
    s_waitcnt lgkmcnt(6)
    v_mfma_f32_16x16x32_bf16 v[92:95], v[108:111], v[36:39], v[92:95]
    ds_read_b64_tr_b16 v[108:109], v118 offset:36864
    ds_read_b64_tr_b16 v[110:111], v118 offset:37376
    s_waitcnt lgkmcnt(6)
    v_mfma_f32_16x16x32_bf16 v[96:99], v[112:115], v[36:39], v[96:99]
    ds_read_b64_tr_b16 v[112:113], v119 offset:36864
    ds_read_b64_tr_b16 v[114:115], v119 offset:37376
    s_waitcnt lgkmcnt(6)
    v_mfma_f32_16x16x32_bf16 v[84:87], v[100:103], v[40:43], v[84:87]
    s_waitcnt lgkmcnt(4)
    v_mfma_f32_16x16x32_bf16 v[88:91], v[104:107], v[40:43], v[88:91]
    s_waitcnt lgkmcnt(2)
    v_mfma_f32_16x16x32_bf16 v[92:95], v[108:111], v[40:43], v[92:95]
    s_waitcnt lgkmcnt(0)
    v_mfma_f32_16x16x32_bf16 v[96:99], v[112:115], v[40:43], v[96:99]
o_c1:
    s_bitcmp1_b32 s35, 16
    s_cbranch_scc0 o_c2
    ds_read_b64_tr_b16 v[100:101], v116 offset:40960
    ds_read_b64_tr_b16 v[102:103], v116 offset:41472
    ds_read_b64_tr_b16 v[104:105], v117 offset:40960
    ds_read_b64_tr_b16 v[106:107], v117 offset:41472
    ds_read_b64_tr_b16 v[108:109], v118 offset:40960
    ds_read_b64_tr_b16 v[110:111], v118 offset:41472
    ds_read_b64_tr_b16 v[112:113], v119 offset:40960
    ds_read_b64_tr_b16 v[114:115], v119 offset:41472
    s_cmp_eq_u32 s36, 0
    s_cbranch_scc1 o_c2w
    s_lshr_b32 s33, s35, 24
    s_bcnt1_i32_b32 s33, s33
    s_waitcnt vmcnt(5)
    s_cmp_eq_u32 s33, 1
    s_cbranch_scc1 o_c2w
    s_waitcnt vmcnt(0)
o_c2w:
    s_waitcnt lgkmcnt(6)
    v_mfma_f32_16x16x32_bf16 v[84:87], v[100:103], v[44:47], v[84:87]
    ds_read_b64_tr_b16 v[100:101], v116 offset:45056
    ds_read_b64_tr_b16 v[102:103], v116 offset:45568
    s_waitcnt lgkmcnt(6)
    v_mfma_f32_16x16x32_bf16 v[88:91], v[104:107], v[44:47], v[88:91]
    ds_read_b64_tr_b16 v[104:105], v117 offset:45056
    ds_read_b64_tr_b16 v[106:107], v117 offset:45568
    s_waitcnt lgkmcnt(6)
    v_mfma_f32_16x16x32_bf16 v[92:95], v[108:111], v[44:47], v[92:95]
    ds_read_b64_tr_b16 v[108:109], v118 offset:45056
    ds_read_b64_tr_b16 v[110:111], v118 offset:45568
    s_waitcnt lgkmcnt(6)
    v_mfma_f32_16x16x32_bf16 v[96:99], v[112:115], v[44:47], v[96:99]
    ds_read_b64_tr_b16 v[112:113], v119 offset:45056
    ds_read_b64_tr_b16 v[114:115], v119 offset:45568
    s_waitcnt lgkmcnt(6)
    v_mfma_f32_16x16x32_bf16 v[84:87], v[100:103], v[48:51], v[84:87]
    ds_read_b64_tr_b16 v[100:101], v116 offset:49152
    ds_read_b64_tr_b16 v[102:103], v116 offset:49664
    s_waitcnt lgkmcnt(6)
    v_mfma_f32_16x16x32_bf16 v[88:91], v[104:107], v[48:51], v[88:91]
    ds_read_b64_tr_b16 v[104:105], v117 offset:49152
    ds_read_b64_tr_b16 v[106:107], v117 offset:49664
    s_waitcnt lgkmcnt(6)
    v_mfma_f32_16x16x32_bf16 v[92:95], v[108:111], v[48:51], v[92:95]
    ds_read_b64_tr_b16 v[108:109], v118 offset:49152
    ds_read_b64_tr_b16 v[110:111], v118 offset:49664
    s_waitcnt lgkmcnt(6)
    v_mfma_f32_16x16x32_bf16 v[96:99], v[112:115], v[48:51], v[96:99]
    ds_read_b64_tr_b16 v[112:113], v119 offset:49152
    ds_read_b64_tr_b16 v[114:115], v119 offset:49664
    s_waitcnt lgkmcnt(6)
    v_mfma_f32_16x16x32_bf16 v[84:87], v[100:103], v[52:55], v[84:87]
    ds_read_b64_tr_b16 v[100:101], v116 offset:53248
    ds_read_b64_tr_b16 v[102:103], v116 offset:53760
    s_waitcnt lgkmcnt(6)
    v_mfma_f32_16x16x32_bf16 v[88:91], v[104:107], v[52:55], v[88:91]
    ds_read_b64_tr_b16 v[104:105], v117 offset:53248
    ds_read_b64_tr_b16 v[106:107], v117 offset:53760
    s_waitcnt lgkmcnt(6)
    v_mfma_f32_16x16x32_bf16 v[92:95], v[108:111], v[52:55], v[92:95]
    ds_read_b64_tr_b16 v[108:109], v118 offset:53248
    ds_read_b64_tr_b16 v[110:111], v118 offset:53760
    s_waitcnt lgkmcnt(6)
    v_mfma_f32_16x16x32_bf16 v[96:99], v[112:115], v[52:55], v[96:99]
    ds_read_b64_tr_b16 v[112:113], v119 offset:53248
    ds_read_b64_tr_b16 v[114:115], v119 offset:53760
    s_waitcnt lgkmcnt(6)
    v_mfma_f32_16x16x32_bf16 v[84:87], v[100:103], v[56:59], v[84:87]
    ds_read_b64_tr_b16 v[100:101], v116 offset:57344
    ds_read_b64_tr_b16 v[102:103], v116 offset:57856
    s_waitcnt lgkmcnt(6)
    v_mfma_f32_16x16x32_bf16 v[88:91], v[104:107], v[56:59], v[88:91]
    ds_read_b64_tr_b16 v[104:105], v117 offset:57344
    ds_read_b64_tr_b16 v[106:107], v117 offset:57856
    s_waitcnt lgkmcnt(6)
    v_mfma_f32_16x16x32_bf16 v[92:95], v[108:111], v[56:59], v[92:95]
    ds_read_b64_tr_b16 v[108:109], v118 offset:57344
    ds_read_b64_tr_b16 v[110:111], v118 offset:57856
    s_waitcnt lgkmcnt(6)
    v_mfma_f32_16x16x32_bf16 v[96:99], v[112:115], v[56:59], v[96:99]
    ds_read_b64_tr_b16 v[112:113], v119 offset:57344
    ds_read_b64_tr_b16 v[114:115], v119 offset:57856
    s_waitcnt lgkmcnt(6)
    v_mfma_f32_16x16x32_bf16 v[84:87], v[100:103], v[60:63], v[84:87]
    s_waitcnt lgkmcnt(4)
    v_mfma_f32_16x16x32_bf16 v[88:91], v[104:107], v[60:63], v[88:91]
    s_waitcnt lgkmcnt(2)
    v_mfma_f32_16x16x32_bf16 v[92:95], v[108:111], v[60:63], v[92:95]
    s_waitcnt lgkmcnt(0)
    v_mfma_f32_16x16x32_bf16 v[96:99], v[112:115], v[60:63], v[96:99]
o_c2:
    s_bitcmp1_b32 s35, 24
    s_cbranch_scc0 o_c3
    ds_read_b64_tr_b16 v[100:101], v120 offset:28672
    ds_read_b64_tr_b16 v[102:103], v120 offset:29184
    ds_read_b64_tr_b16 v[104:105], v121 offset:28672
    ds_read_b64_tr_b16 v[106:107], v121 offset:29184
    ds_read_b64_tr_b16 v[108:109], v122 offset:28672
    ds_read_b64_tr_b16 v[110:111], v122 offset:29184
    ds_read_b64_tr_b16 v[112:113], v123 offset:28672
    ds_read_b64_tr_b16 v[114:115], v123 offset:29184
    s_cmp_eq_u32 s36, 0
    s_cbranch_scc1 o_c3w
    s_waitcnt vmcnt(0)
o_c3w:
    s_waitcnt lgkmcnt(6)
    v_mfma_f32_16x16x32_bf16 v[84:87], v[100:103], v[64:67], v[84:87]
    ds_read_b64_tr_b16 v[100:101], v120 offset:32768
    ds_read_b64_tr_b16 v[102:103], v120 offset:33280
    s_waitcnt lgkmcnt(6)
    v_mfma_f32_16x16x32_bf16 v[88:91], v[104:107], v[64:67], v[88:91]
    ds_read_b64_tr_b16 v[104:105], v121 offset:32768
    ds_read_b64_tr_b16 v[106:107], v121 offset:33280
    s_waitcnt lgkmcnt(6)
    v_mfma_f32_16x16x32_bf16 v[92:95], v[108:111], v[64:67], v[92:95]
    ds_read_b64_tr_b16 v[108:109], v122 offset:32768
    ds_read_b64_tr_b16 v[110:111], v122 offset:33280
    s_waitcnt lgkmcnt(6)
    v_mfma_f32_16x16x32_bf16 v[96:99], v[112:115], v[64:67], v[96:99]
    ds_read_b64_tr_b16 v[112:113], v123 offset:32768
    ds_read_b64_tr_b16 v[114:115], v123 offset:33280
    s_waitcnt lgkmcnt(6)
    v_mfma_f32_16x16x32_bf16 v[84:87], v[100:103], v[68:71], v[84:87]
    ds_read_b64_tr_b16 v[100:101], v120 offset:36864
    ds_read_b64_tr_b16 v[102:103], v120 offset:37376
    s_waitcnt lgkmcnt(6)
    v_mfma_f32_16x16x32_bf16 v[88:91], v[104:107], v[68:71], v[88:91]
    ds_read_b64_tr_b16 v[104:105], v121 offset:36864
    ds_read_b64_tr_b16 v[106:107], v121 offset:37376
    s_waitcnt lgkmcnt(6)
    v_mfma_f32_16x16x32_bf16 v[92:95], v[108:111], v[68:71], v[92:95]
    ds_read_b64_tr_b16 v[108:109], v122 offset:36864
    ds_read_b64_tr_b16 v[110:111], v122 offset:37376
    s_waitcnt lgkmcnt(6)
    v_mfma_f32_16x16x32_bf16 v[96:99], v[112:115], v[68:71], v[96:99]
    ds_read_b64_tr_b16 v[112:113], v123 offset:36864
    ds_read_b64_tr_b16 v[114:115], v123 offset:37376
    s_waitcnt lgkmcnt(6)
    v_mfma_f32_16x16x32_bf16 v[84:87], v[100:103], v[72:75], v[84:87]
    ds_read_b64_tr_b16 v[100:101], v120 offset:40960
    ds_read_b64_tr_b16 v[102:103], v120 offset:41472
    s_waitcnt lgkmcnt(6)
    v_mfma_f32_16x16x32_bf16 v[88:91], v[104:107], v[72:75], v[88:91]
    ds_read_b64_tr_b16 v[104:105], v121 offset:40960
    ds_read_b64_tr_b16 v[106:107], v121 offset:41472
    s_waitcnt lgkmcnt(6)
    v_mfma_f32_16x16x32_bf16 v[92:95], v[108:111], v[72:75], v[92:95]
    ds_read_b64_tr_b16 v[108:109], v122 offset:40960
    ds_read_b64_tr_b16 v[110:111], v122 offset:41472
    s_waitcnt lgkmcnt(6)
    v_mfma_f32_16x16x32_bf16 v[96:99], v[112:115], v[72:75], v[96:99]
    ds_read_b64_tr_b16 v[112:113], v123 offset:40960
    ds_read_b64_tr_b16 v[114:115], v123 offset:41472
    s_waitcnt lgkmcnt(6)
    v_mfma_f32_16x16x32_bf16 v[84:87], v[100:103], v[76:79], v[84:87]
    ds_read_b64_tr_b16 v[100:101], v120 offset:45056
    ds_read_b64_tr_b16 v[102:103], v120 offset:45568
    s_waitcnt lgkmcnt(6)
    v_mfma_f32_16x16x32_bf16 v[88:91], v[104:107], v[76:79], v[88:91]
    ds_read_b64_tr_b16 v[104:105], v121 offset:45056
    ds_read_b64_tr_b16 v[106:107], v121 offset:45568
    s_waitcnt lgkmcnt(6)
    v_mfma_f32_16x16x32_bf16 v[92:95], v[108:111], v[76:79], v[92:95]
    ds_read_b64_tr_b16 v[108:109], v122 offset:45056
    ds_read_b64_tr_b16 v[110:111], v122 offset:45568
    s_waitcnt lgkmcnt(6)
    v_mfma_f32_16x16x32_bf16 v[96:99], v[112:115], v[76:79], v[96:99]
    ds_read_b64_tr_b16 v[112:113], v123 offset:45056
    ds_read_b64_tr_b16 v[114:115], v123 offset:45568
    s_waitcnt lgkmcnt(6)
    v_mfma_f32_16x16x32_bf16 v[84:87], v[100:103], v[80:83], v[84:87]
    s_waitcnt lgkmcnt(4)
    v_mfma_f32_16x16x32_bf16 v[88:91], v[104:107], v[80:83], v[88:91]
    s_waitcnt lgkmcnt(2)
    v_mfma_f32_16x16x32_bf16 v[92:95], v[108:111], v[80:83], v[92:95]
    s_waitcnt lgkmcnt(0)
    v_mfma_f32_16x16x32_bf16 v[96:99], v[112:115], v[80:83], v[96:99]
o_c3:
    s_cmp_eq_u32 s36, 0
    s_cbranch_scc1 o_loop
o_done:
    s_lshl_b32 s33, s18, 8
    s_add_u32 s33, s33, 2560
    s_nop 7
    buffer_store_dwordx4 v[84:87], v126, s[92:95], s33 offen offset:0 sc1 nt
    buffer_store_dwordx4 v[88:91], v126, s[92:95], s33 offen offset:64 sc1 nt
    buffer_store_dwordx4 v[92:95], v126, s[92:95], s33 offen offset:128 sc1 nt
    buffer_store_dwordx4 v[96:99], v126, s[92:95], s33 offen offset:192 sc1 nt
    s_endpgm
a_sw:
    s_sleep 1
    ds_read_b32 v3, v0
    s_waitcnt lgkmcnt(0)
    v_readfirstlane_b32 s33, v3
    s_nop 0
    s_cmp_lt_u32 s33, s32
    s_cbranch_scc1 a_sw
    s_branch a_swd
a_nodma:
    s_cmp_lg_u32 s26, 6
    s_cbranch_scc1 a_l0
    s_cmp_lg_u32 s14, 0
    s_cbranch_scc1 a_l0
    v_mov_b32 v116, 0
    v_mov_b32 v117, 1
    s_mov_b64 exec, 1
    buffer_atomic_add v117, v116, s[84:87], 0 offen sc1
    s_mov_b64 exec, -1
a_l0:
    s_cmp_lt_u32 s71, 12
    s_cbranch_scc1 a_nodma2
    s_cmp_eq_u32 s26, 7
    s_cbranch_scc1 a_l2
    s_mul_i32 s33, s14, 30720
    s_add_u32 s33, s33, s73
    s_add_u32 m0, s24, 49152
    s_add_u32 s81, s33, 491520
    buffer_load_dwordx4 v98, s[76:79], s81 offen lds
    s_add_u32 m0, s24, 50176
    s_add_u32 s81, s33, 501760
    buffer_load_dwordx4 v99, s[76:79], s81 offen lds
    s_add_u32 m0, s24, 51200
    s_add_u32 s81, s33, 512000
    buffer_load_dwordx4 v98, s[76:79], s81 offen lds
    s_branch a_nodma2
a_l2:
    s_mul_i32 s33, s14, 30720
    s_add_u32 s33, s33, s73
    s_add_u32 m0, s24, 0
    s_add_u32 s81, s33, 0
    buffer_load_dwordx4 v98, s[76:79], s81 offen lds
    s_add_u32 m0, s24, 1024
    s_add_u32 s81, s33, 10240
    buffer_load_dwordx4 v99, s[76:79], s81 offen lds
    s_add_u32 m0, s24, 2048
    s_add_u32 s81, s33, 20480
    buffer_load_dwordx4 v98, s[76:79], s81 offen lds
    s_branch a_nodma2
a_slow:
    v_lshlrev_b32 v120, 15, v113
    v_lshl_add_u32 v120, v112, 4, v120
    v_lshlrev_b32 v121, 4, v112
    v_mul_u32_u24 v124, 320, v113
    v_lshl_add_u32 v124, v112, 4, v124
    v_mov_b32 v125, 0xff800000
    s_mov_b32 s27, 0
    v_mov_b32 v20, 0
    v_mov_b32 v21, 0
    v_mov_b32 v22, 0
    v_mov_b32 v23, 0
    v_mov_b32 v24, 0
    v_mov_b32 v25, 0
    v_mov_b32 v26, 0
    v_mov_b32 v27, 0
    v_mov_b32 v28, 0
    v_mov_b32 v29, 0
    v_mov_b32 v30, 0
    v_mov_b32 v31, 0
    v_mov_b32 v32, 0
    v_mov_b32 v33, 0
    v_mov_b32 v34, 0
    v_mov_b32 v35, 0
    s_cmp_eq_u32 s16, 0
    s_cbranch_scc1 a_spass
    v_mov_b32 v4, v12
    v_mov_b32 v5, v13
    v_mov_b32 v6, v14
    v_mov_b32 v7, v15
    v_mov_b32 v8, v16
    v_mov_b32 v9, v17
    v_mov_b32 v10, v18
    v_mov_b32 v11, v19
a_spass:
    s_add_u32 s20, s31, 80
    s_lshl_b32 s20, s20, 15
    s_add_u32 s21, s30, 80
    s_lshl_b32 s21, s21, 15
    s_lshl_b32 s33, s29, 3
    s_add_u32 s21, s21, s33
    s_mul_i32 s22, s12, 81920
    s_add_u32 s22, s22, 5242880
    s_mov_b32 s26, 0
a_sloop:
    buffer_load_dwordx4 v[92:95], v120, s[8:11], s20 offen
    buffer_load_dwordx2 v[96:97], v121, s[8:11], s21 offen
    s_mov_b64 exec, s[18:19]
    buffer_load_dwordx4 v[100:103], v124, s[8:11], s22 offen
    buffer_load_dwordx4 v[104:107], v124, s[8:11], s22 offen offset:640
    s_mov_b64 exec, -1
    s_waitcnt vmcnt(0)
    v_mfma_f32_32x32x16_bf16 v[52:67], v[92:95], v[4:7], 0
    v_mfma_f32_32x32x8_bf16 v[52:67], v[96:97], v[8:9], v[52:67]
    s_nop 7
    s_nop 7
    s_cmp_eq_u32 s27, 0
    s_cbranch_scc0 a_sp2
    v_max3_f32 v125, v125, v52, v53
    v_max3_f32 v125, v125, v54, v55
    v_max3_f32 v125, v125, v56, v57
    v_max3_f32 v125, v125, v58, v59
    v_max3_f32 v125, v125, v60, v61
    v_max3_f32 v125, v125, v62, v63
    v_max3_f32 v125, v125, v64, v65
    v_max3_f32 v125, v125, v66, v67
    s_branch a_snext
a_sp2:
    v_sub_f32 v52, v52, v125
    v_sub_f32 v53, v53, v125
    v_sub_f32 v54, v54, v125
    v_sub_f32 v55, v55, v125
    v_sub_f32 v56, v56, v125
    v_sub_f32 v57, v57, v125
    v_sub_f32 v58, v58, v125
    v_sub_f32 v59, v59, v125
    v_sub_f32 v60, v60, v125
    v_sub_f32 v61, v61, v125
    v_sub_f32 v62, v62, v125
    v_sub_f32 v63, v63, v125
    v_sub_f32 v64, v64, v125
    v_sub_f32 v65, v65, v125
    v_sub_f32 v66, v66, v125
    v_sub_f32 v67, v67, v125
    v_exp_f32 v52, v52
    v_exp_f32 v53, v53
    v_exp_f32 v54, v54
    v_exp_f32 v55, v55
    v_exp_f32 v56, v56
    v_exp_f32 v57, v57
    v_exp_f32 v58, v58
    v_exp_f32 v59, v59
    v_exp_f32 v60, v60
    v_exp_f32 v61, v61
    v_exp_f32 v62, v62
    v_exp_f32 v63, v63
    v_exp_f32 v64, v64
    v_exp_f32 v65, v65
    v_exp_f32 v66, v66
    v_exp_f32 v67, v67
    v_cvt_pk_bf16_f32 v84, v52, v53
    v_cvt_pk_bf16_f32 v85, v54, v55
    v_cvt_pk_bf16_f32 v86, v56, v57
    v_cvt_pk_bf16_f32 v87, v58, v59
    v_cvt_pk_bf16_f32 v88, v60, v61
    v_cvt_pk_bf16_f32 v89, v62, v63
    v_cvt_pk_bf16_f32 v90, v64, v65
    v_cvt_pk_bf16_f32 v91, v66, v67
    v_mfma_f32_32x32x16_bf16 v[20:35], v[100:103], v[84:87], v[20:35]
    s_nop 0
    v_mfma_f32_32x32x16_bf16 v[20:35], v[104:107], v[88:91], v[20:35]
a_snext:
    s_add_u32 s20, s20, 512
    s_add_u32 s21, s21, 512
    s_add_u32 s22, s22, 1280
    s_add_u32 s26, s26, 1
    s_nop 7
    s_cmp_lt_u32 s26, 64
    s_cbranch_scc1 a_sloop
    s_cmp_eq_u32 s27, 1
    s_cbranch_scc1 a_sdone
    v_mov_b32 v126, v125
    v_mov_b32 v127, v125
    s_nop 1
    v_permlane32_swap_b32 v126, v127
    v_max3_f32 v125, v125, v126, v127
    s_mov_b32 s27, 1
    s_branch a_spass
a_sdone:
    s_mov_b32 s26, 99
    s_nop 7
    s_nop 3
    v_mov_b32 v68, v20
    v_mov_b32 v69, v21
    v_mov_b32 v70, v22
    v_mov_b32 v71, v23
    v_mov_b32 v72, v24
    v_mov_b32 v73, v25
    v_mov_b32 v74, v26
    v_mov_b32 v75, v27
    v_mov_b32 v76, v28
    v_mov_b32 v77, v29
    v_mov_b32 v78, v30
    v_mov_b32 v79, v31
    s_branch a_fin
a_bi:
    s_cmp_ge_u32 s26, 6
    s_cselect_b32 s38, 0, s38
    s_cbranch_scc1 a_nb1
    buffer_load_dwordx4 v[116:119], v111, s[8:11], s72 offen sc1
    s_branch a_nb1
a_bchk:
    v_xor_b32 v116, s80, v116
    v_xor_b32 v117, s80, v117
    v_xor_b32 v118, s80, v118
    v_xor_b32 v119, s80, v119
    v_or3_b32 v116, v116, v117, v118
    v_or_b32 v116, v116, v119
    v_cmp_ne_u32 vcc, 0, v116
    s_and_b32 s41, s75, 0x101
    s_lshl_b32 s41, s41, s68
    s_lshl_b32 s40, s41, 16
    s_and_b64 s[42:43], vcc, s[74:75]
    s_cselect_b32 s38, 1, 0
    s_and_b64 vcc, vcc, s[40:41]
    s_cbranch_scc0 a_bok
    s_mov_b32 s33, 0
pf_1:
    buffer_load_dwordx4 v[116:119], v111, s[8:11], s72 offen sc1
    s_add_u32 s33, s33, 1
    s_waitcnt vmcnt(0)
    v_xor_b32 v116, s80, v116
    v_xor_b32 v117, s80, v117
    v_xor_b32 v118, s80, v118
    v_xor_b32 v119, s80, v119
    v_or3_b32 v116, v116, v117, v118
    v_or_b32 v116, v116, v119
    v_cmp_ne_u32 vcc, 0, v116
    s_nop 0
    s_and_b64 vcc, vcc, s[40:41]
    s_cbranch_scc0 pf_1_d
    s_sleep 1
    s_cmp_lt_u32 s33, 200000
    s_cbranch_scc1 pf_1
pf_1_d:
    s_branch a_bok
m_s:
    s_setprio 0
    s_cmp_lt_u32 s71, 12
    s_cbranch_scc1 m_sy
    s_cmp_ge_u32 s14, 4
    s_cbranch_scc1 l_bu
    s_branch c_bu
m_sy:
    s_waitcnt lgkmcnt(0)
    s_add_u32 s6, s4, 12517376
    s_addc_u32 s7, s5, 0
    s_load_dword s80, s[6:7], 0
    s_mov_b32 s8, s4
    s_and_b32 s9, s5, 0xffff
    s_mov_b32 s10, 0x1600000
    s_mov_b32 s11, 0x00020000
    s_mov_b32 s92, s88
    s_and_b32 s93, s89, 0xffff
    s_mov_b32 s94, 0xa00000
    s_mov_b32 s95, 0x00020000
    s_mov_b32 s84, s90
    s_and_b32 s85, s91, 0xffff
    s_mov_b32 s86, 0x100
    s_mov_b32 s87, 0x00020000
    v_mov_b32 v4, 0
    ds_write_b32 v4, v4
    s_waitcnt lgkmcnt(0)
    s_add_u32 s80, s80, 1
    s_barrier
    s_and_b32 s30, s71, 30
    s_cmp_eq_u32 s30, 10
    s_cbranch_scc1 s_idle
    s_cmp_lt_u32 s14, 4
    s_cbranch_scc1 c_y
    s_sleep 127
    s_sleep 127
    s_sleep 127
    s_branch l_y
l_bu:
    s_load_dwordx2 s[16:17], s[0:1], 0
    s_load_dwordx4 s[20:23], s[0:1], 24
    s_sub_u32 s30, s71, 12
    s_and_b32 s12, s70, 3
    s_lshl_b32 s12, s12, 2
    s_and_b32 s13, s30, 3
    s_add_u32 s12, s12, s13
    s_lshr_b32 s13, s70, 2
    s_mul_i32 s13, s13, 5
    s_lshr_b32 s31, s30, 2
    s_add_u32 s13, s13, s31
    s_lshr_b32 s30, s15, 1
    s_and_b32 s31, s15, 1
    s_lshl_b32 s34, s12, 7
    s_lshl_b32 s35, s30, 6
    s_add_u32 s34, s34, s35
    s_lshl_b32 s35, s31, 4
    s_add_u32 s34, s34, s35
    s_mul_i32 s34, s34, 1280
    v_lshrrev_b32 v3, 5, v2
    v_bfe_u32 v12, v2, 3, 2
    v_lshl_add_u32 v3, v3, 5, v12
    v_mul_u32_u24 v3, 1280, v3
    v_add_u32 v3, s34, v3
    v_lshrrev_b32 v12, 4, v2
    v_and_b32 v13, 7, v2
    v_xor_b32 v12, v12, v13
    v_xor_b32 v13, 4, v12
    v_lshl_add_u32 v4, v12, 4, v3
    v_lshl_add_u32 v5, v13, 4, v3
    v_add_u32 v5, 4096, v5
    v_add_u32 v6, 8192, v4
    v_add_u32 v7, 8192, v5
    s_lshl_b32 s34, s13, 6
    s_lshl_b32 s35, s30, 5
    s_add_u32 s34, s34, s35
    s_mul_i32 s34, s34, 1280
    v_lshrrev_b32 v3, 3, v2
    v_mul_u32_u24 v3, 1280, v3
    v_add_u32 v3, s34, v3
    v_lshrrev_b32 v12, 4, v2
    v_and_b32 v13, 7, v2
    v_xor_b32 v12, v12, v13
    v_xor_b32 v13, 4, v12
    v_lshl_add_u32 v8, v12, 4, v3
    v_lshl_add_u32 v9, v13, 4, v3
    v_add_u32 v9, 9216, v9
    v_add_u32 v10, 18432, v8
    v_add_u32 v11, 18432, v9
    s_waitcnt lgkmcnt(0)
    s_cmp_eq_u32 s31, 0
    s_cselect_b32 s18, s20, s22
    s_cselect_b32 s19, s21, s23
    s_mov_b32 s36, s16
    s_and_b32 s37, s17, 0xffff
    s_mov_b32 s38, 0x280000
    s_mov_b32 s39, 0x00020000
    s_mov_b32 s40, s18
    s_and_b32 s41, s19, 0xffff
    s_mov_b32 s42, 0xc8000
    s_mov_b32 s43, 0x00020000
    s_sub_u32 s30, s71, 12
    s_and_b32 s34, s30, 3
    s_mul_i32 s34, s34, 5
    s_add_u32 s34, s34, 1
    s_lshr_b32 s34, s34, 1
    s_lshr_b32 s35, s30, 2
    s_lshl_b32 s35, s35, 1
    s_add_u32 s34, s34, s35
    s_add_u32 s34, s34, s70
    s_cmp_ge_u32 s34, 10
    s_cselect_b32 s3, 10, 0
    s_sub_u32 s34, s34, s3
    s_cmp_ge_u32 s34, 10
    s_cselect_b32 s3, 10, 0
    s_sub_u32 s34, s34, s3
    s_lshl_b32 s34, s34, 7
    s_mov_b32 s35, s34
    s_add_u32 m0, s33, 0
    s_nop 0
    buffer_load_dwordx4 v4, s[36:39], s34 offen offset:0 lds
    buffer_load_dwordx4 v5, s[36:39], s34 offen offset:1024 lds
    buffer_load_dwordx4 v6, s[36:39], s34 offen offset:2048 lds
    buffer_load_dwordx4 v7, s[36:39], s34 offen offset:3072 lds
    s_add_u32 s34, s34, 128
    s_cmp_eq_u32 s34, 1280
    s_cselect_b32 s34, 0, s34
    s_add_u32 m0, s33, 16384
    s_nop 0
    buffer_load_dwordx4 v8, s[40:43], s35 offen offset:0 lds
    buffer_load_dwordx4 v9, s[40:43], s35 offen offset:1024 lds
    buffer_load_dwordx4 v10, s[40:43], s35 offen offset:2048 lds
    buffer_load_dwordx4 v11, s[40:43], s35 offen offset:3072 lds
    s_add_u32 s35, s35, 128
    s_cmp_eq_u32 s35, 1280
    s_cselect_b32 s35, 0, s35
    s_add_u32 m0, s33, 32768
    s_nop 0
    buffer_load_dwordx4 v4, s[36:39], s34 offen offset:0 lds
    buffer_load_dwordx4 v5, s[36:39], s34 offen offset:1024 lds
    buffer_load_dwordx4 v6, s[36:39], s34 offen offset:2048 lds
    buffer_load_dwordx4 v7, s[36:39], s34 offen offset:3072 lds
    s_add_u32 s34, s34, 128
    s_cmp_eq_u32 s34, 1280
    s_cselect_b32 s34, 0, s34
    s_add_u32 m0, s33, 49152
    s_nop 0
    buffer_load_dwordx4 v8, s[40:43], s35 offen offset:0 lds
    buffer_load_dwordx4 v9, s[40:43], s35 offen offset:1024 lds
    buffer_load_dwordx4 v10, s[40:43], s35 offen offset:2048 lds
    buffer_load_dwordx4 v11, s[40:43], s35 offen offset:3072 lds
    s_add_u32 s35, s35, 128
    s_cmp_eq_u32 s35, 1280
    s_cselect_b32 s35, 0, s35
    s_waitcnt vmcnt(8)
    s_barrier
    s_add_u32 m0, s33, 65536
    s_nop 0
    buffer_load_dwordx4 v4, s[36:39], s34 offen offset:0 lds
    buffer_load_dwordx4 v5, s[36:39], s34 offen offset:1024 lds
    buffer_load_dwordx4 v6, s[36:39], s34 offen offset:2048 lds
    buffer_load_dwordx4 v7, s[36:39], s34 offen offset:3072 lds
    s_add_u32 s34, s34, 128
    s_cmp_eq_u32 s34, 1280
    s_cselect_b32 s34, 0, s34
    s_waitcnt vmcnt(4)
    s_barrier
    s_add_u32 m0, s33, 0
    s_nop 0
    buffer_load_dwordx4 v8, s[40:43], s35 offen offset:0 lds
    buffer_load_dwordx4 v9, s[40:43], s35 offen offset:1024 lds
    buffer_load_dwordx4 v10, s[40:43], s35 offen offset:2048 lds
    buffer_load_dwordx4 v11, s[40:43], s35 offen offset:3072 lds
    s_add_u32 s35, s35, 128
    s_cmp_eq_u32 s35, 1280
    s_cselect_b32 s35, 0, s35
    s_add_u32 m0, s33, 16384
    s_nop 0
    buffer_load_dwordx4 v4, s[36:39], s34 offen offset:0 lds
    buffer_load_dwordx4 v5, s[36:39], s34 offen offset:1024 lds
    buffer_load_dwordx4 v6, s[36:39], s34 offen offset:2048 lds
    buffer_load_dwordx4 v7, s[36:39], s34 offen offset:3072 lds
    s_add_u32 s34, s34, 128
    s_cmp_eq_u32 s34, 1280
    s_cselect_b32 s34, 0, s34
    s_waitcnt vmcnt(4)
    s_barrier
    s_add_u32 m0, s33, 32768
    s_nop 0
    buffer_load_dwordx4 v8, s[40:43], s35 offen offset:0 lds
    buffer_load_dwordx4 v9, s[40:43], s35 offen offset:1024 lds
    buffer_load_dwordx4 v10, s[40:43], s35 offen offset:2048 lds
    buffer_load_dwordx4 v11, s[40:43], s35 offen offset:3072 lds
    s_add_u32 s35, s35, 128
    s_cmp_eq_u32 s35, 1280
    s_cselect_b32 s35, 0, s35
    s_add_u32 m0, s33, 49152
    s_nop 0
    buffer_load_dwordx4 v4, s[36:39], s34 offen offset:0 lds
    buffer_load_dwordx4 v5, s[36:39], s34 offen offset:1024 lds
    buffer_load_dwordx4 v6, s[36:39], s34 offen offset:2048 lds
    buffer_load_dwordx4 v7, s[36:39], s34 offen offset:3072 lds
    s_add_u32 s34, s34, 128
    s_cmp_eq_u32 s34, 1280
    s_cselect_b32 s34, 0, s34
    s_waitcnt vmcnt(4)
    s_barrier
    s_add_u32 m0, s33, 65536
    s_nop 0
    buffer_load_dwordx4 v8, s[40:43], s35 offen offset:0 lds
    buffer_load_dwordx4 v9, s[40:43], s35 offen offset:1024 lds
    buffer_load_dwordx4 v10, s[40:43], s35 offen offset:2048 lds
    buffer_load_dwordx4 v11, s[40:43], s35 offen offset:3072 lds
    s_add_u32 s35, s35, 128
    s_cmp_eq_u32 s35, 1280
    s_cselect_b32 s35, 0, s35
    s_add_u32 m0, s33, 0
    s_nop 0
    buffer_load_dwordx4 v4, s[36:39], s34 offen offset:0 lds
    buffer_load_dwordx4 v5, s[36:39], s34 offen offset:1024 lds
    buffer_load_dwordx4 v6, s[36:39], s34 offen offset:2048 lds
    buffer_load_dwordx4 v7, s[36:39], s34 offen offset:3072 lds
    s_add_u32 s34, s34, 128
    s_cmp_eq_u32 s34, 1280
    s_cselect_b32 s34, 0, s34
    s_waitcnt vmcnt(4)
    s_barrier
    s_add_u32 m0, s33, 16384
    s_nop 0
    buffer_load_dwordx4 v8, s[40:43], s35 offen offset:0 lds
    buffer_load_dwordx4 v9, s[40:43], s35 offen offset:1024 lds
    buffer_load_dwordx4 v10, s[40:43], s35 offen offset:2048 lds
    buffer_load_dwordx4 v11, s[40:43], s35 offen offset:3072 lds
    s_add_u32 s35, s35, 128
    s_cmp_eq_u32 s35, 1280
    s_cselect_b32 s35, 0, s35
    s_add_u32 m0, s33, 32768
    s_nop 0
    buffer_load_dwordx4 v4, s[36:39], s34 offen offset:0 lds
    buffer_load_dwordx4 v5, s[36:39], s34 offen offset:1024 lds
    buffer_load_dwordx4 v6, s[36:39], s34 offen offset:2048 lds
    buffer_load_dwordx4 v7, s[36:39], s34 offen offset:3072 lds
    s_add_u32 s34, s34, 128
    s_cmp_eq_u32 s34, 1280
    s_cselect_b32 s34, 0, s34
    s_waitcnt vmcnt(4)
    s_barrier
    s_add_u32 m0, s33, 49152
    s_nop 0
    buffer_load_dwordx4 v8, s[40:43], s35 offen offset:0 lds
    buffer_load_dwordx4 v9, s[40:43], s35 offen offset:1024 lds
    buffer_load_dwordx4 v10, s[40:43], s35 offen offset:2048 lds
    buffer_load_dwordx4 v11, s[40:43], s35 offen offset:3072 lds
    s_add_u32 s35, s35, 128
    s_cmp_eq_u32 s35, 1280
    s_cselect_b32 s35, 0, s35
    s_add_u32 m0, s33, 65536
    s_nop 0
    buffer_load_dwordx4 v4, s[36:39], s34 offen offset:0 lds
    buffer_load_dwordx4 v5, s[36:39], s34 offen offset:1024 lds
    buffer_load_dwordx4 v6, s[36:39], s34 offen offset:2048 lds
    buffer_load_dwordx4 v7, s[36:39], s34 offen offset:3072 lds
    s_add_u32 s34, s34, 128
    s_cmp_eq_u32 s34, 1280
    s_cselect_b32 s34, 0, s34
    s_waitcnt vmcnt(4)
    s_barrier
    s_add_u32 m0, s33, 0
    s_nop 0
    buffer_load_dwordx4 v8, s[40:43], s35 offen offset:0 lds
    buffer_load_dwordx4 v9, s[40:43], s35 offen offset:1024 lds
    buffer_load_dwordx4 v10, s[40:43], s35 offen offset:2048 lds
    buffer_load_dwordx4 v11, s[40:43], s35 offen offset:3072 lds
    s_add_u32 s35, s35, 128
    s_cmp_eq_u32 s35, 1280
    s_cselect_b32 s35, 0, s35
    s_add_u32 m0, s33, 16384
    s_nop 0
    buffer_load_dwordx4 v4, s[36:39], s34 offen offset:0 lds
    buffer_load_dwordx4 v5, s[36:39], s34 offen offset:1024 lds
    buffer_load_dwordx4 v6, s[36:39], s34 offen offset:2048 lds
    buffer_load_dwordx4 v7, s[36:39], s34 offen offset:3072 lds
    s_add_u32 s34, s34, 128
    s_cmp_eq_u32 s34, 1280
    s_cselect_b32 s34, 0, s34
    s_waitcnt vmcnt(4)
    s_barrier
    s_add_u32 m0, s33, 32768
    s_nop 0
    buffer_load_dwordx4 v8, s[40:43], s35 offen offset:0 lds
    buffer_load_dwordx4 v9, s[40:43], s35 offen offset:1024 lds
    buffer_load_dwordx4 v10, s[40:43], s35 offen offset:2048 lds
    buffer_load_dwordx4 v11, s[40:43], s35 offen offset:3072 lds
    s_add_u32 s35, s35, 128
    s_cmp_eq_u32 s35, 1280
    s_cselect_b32 s35, 0, s35
    s_add_u32 m0, s33, 49152
    s_nop 0
    buffer_load_dwordx4 v4, s[36:39], s34 offen offset:0 lds
    buffer_load_dwordx4 v5, s[36:39], s34 offen offset:1024 lds
    buffer_load_dwordx4 v6, s[36:39], s34 offen offset:2048 lds
    buffer_load_dwordx4 v7, s[36:39], s34 offen offset:3072 lds
    s_add_u32 s34, s34, 128
    s_cmp_eq_u32 s34, 1280
    s_cselect_b32 s34, 0, s34
    s_waitcnt vmcnt(4)
    s_barrier
    s_add_u32 m0, s33, 65536
    s_nop 0
    buffer_load_dwordx4 v8, s[40:43], s35 offen offset:0 lds
    buffer_load_dwordx4 v9, s[40:43], s35 offen offset:1024 lds
    buffer_load_dwordx4 v10, s[40:43], s35 offen offset:2048 lds
    buffer_load_dwordx4 v11, s[40:43], s35 offen offset:3072 lds
    s_add_u32 s35, s35, 128
    s_cmp_eq_u32 s35, 1280
    s_cselect_b32 s35, 0, s35
    s_waitcnt vmcnt(0)
    s_barrier
    s_barrier
    s_endpgm
l_y:
    s_setprio 3
    s_waitcnt vmcnt(0)
    s_lshl_b32 s12, s70, 1
    s_and_b32 s13, s71, 1
    s_add_u32 s12, s12, s13
    s_lshr_b32 s13, s71, 1
    s_load_dwordx2 s[24:25], s[0:1], 0
    s_load_dwordx2 s[26:27], s[0:1], 64
    v_lshrrev_b32 v120, 5, v2
    v_and_b32 v121, 31, v2
    s_lshl_b32 s34, s14, 4
    v_add_u32 v120, s34, v120
    v_mul_u32_u24 v116, 528, v120
    v_lshl_add_u32 v116, v121, 4, v116
    s_lshl_b32 s34, s12, 7
    v_add_u32 v120, s34, v120
    s_lshl_b32 s35, s13, 8
    v_lshl_add_u32 v119, v121, 3, s35
    v_mul_u32_u24 v117, 1280, v120
    v_add_u32 v117, v117, v119
    v_mul_u32_u24 v118, 5120, v120
    v_lshl_add_u32 v118, v119, 1, v118
    s_waitcnt lgkmcnt(0)
    global_load_dwordx2 v[124:125], v119, s[26:27]
    s_mov_b32 s76, s24
    s_and_b32 s77, s25, 0xffff
    s_mov_b32 s78, 0x280000
    s_mov_b32 s79, 0x00020000
    s_waitcnt vmcnt(0)
    v_lshlrev_b32 v120, 16, v124
    v_and_b32 v121, 0xffff0000, v124
    v_lshlrev_b32 v122, 16, v125
    v_and_b32 v123, 0xffff0000, v125
    s_load_dwordx4 s[20:23], s[0:1], 40
    s_lshl_b32 s34, s12, 4
    s_lshl_b32 s35, s15, 2
    s_add_u32 s34, s34, s35
    s_mul_i32 s34, s34, 21504
    s_add_u32 s34, s34, 16777216
    v_xor_b32 v3, 0, v2
    v_lshl_add_u32 v4, v3, 4, s34
    v_xor_b32 v3, 4, v2
    v_lshl_add_u32 v5, v3, 4, s34
    v_add_u32 v5, 20480, v5
    v_xor_b32 v3, 8, v2
    v_lshl_add_u32 v6, v3, 4, s34
    v_add_u32 v6, 40960, v6
    v_xor_b32 v3, 12, v2
    v_lshl_add_u32 v7, v3, 4, s34
    v_add_u32 v7, 61440, v7
    s_lshl_b32 s34, s13, 7
    s_lshl_b32 s35, s15, 5
    s_add_u32 s34, s34, s35
    s_mul_i32 s34, s34, 1280
    v_lshrrev_b32 v3, 5, v2
    v_bfe_u32 v12, v2, 3, 2
    v_lshl_add_u32 v3, v3, 4, v12
    v_mul_u32_u24 v3, 1280, v3
    v_add_u32 v3, s34, v3
    v_lshrrev_b32 v12, 4, v2
    v_and_b32 v13, 7, v2
    v_xor_b32 v12, v12, v13
    v_xor_b32 v13, 4, v12
    v_lshl_add_u32 v8, v12, 4, v3
    v_lshl_add_u32 v9, v13, 4, v3
    v_add_u32 v9, 4096, v9
    v_add_u32 v10, 8192, v8
    v_add_u32 v11, 8192, v9
    s_waitcnt lgkmcnt(0)
    s_mov_b32 s36, s20
    s_and_b32 s37, s21, 0xffff
    s_mov_b32 s38, 0xc8000
    s_mov_b32 s39, 0x00020000
    s_mov_b32 s24, s22
    s_and_b32 s25, s23, 0xffff
    s_mov_b32 s26, 0xc8000
    s_mov_b32 s27, 0x00020000
    s_mov_b32 s42, s38
    s_mov_b32 s43, 0x00020000
    s_cmp_eq_u32 s15, 0
    s_cbranch_scc1 y_poll
    s_and_b32 s35, s71, 1
    s_cmp_eq_u32 s35, 0
    s_cselect_b32 s40, s36, s24
    s_cselect_b32 s41, s37, s25
    v_lshlrev_b32 v16, 7, v2
    v_mov_b32 v18, 0
    s_mul_i32 s34, s13, 163840
    s_sub_u32 s35, s15, 1
    s_mul_i32 s35, s35, 53248
    s_add_u32 s34, s34, s35
    buffer_load_dword v17, v16, s[40:43], s34 offen
    s_add_u32 s34, s34, 8192
    s_waitcnt vmcnt(0)
    s_sleep 1
    ds_read_b32 v19, v18
    s_waitcnt lgkmcnt(0)
    v_readfirstlane_b32 s35, v19
    s_nop 0
    s_cmp_lg_u32 s35, 0
    s_cbranch_scc1 y_poll
    buffer_load_dword v17, v16, s[40:43], s34 offen
    s_add_u32 s34, s34, 8192
    s_waitcnt vmcnt(0)
    s_sleep 1
    ds_read_b32 v19, v18
    s_waitcnt lgkmcnt(0)
    v_readfirstlane_b32 s35, v19
    s_nop 0
    s_cmp_lg_u32 s35, 0
    s_cbranch_scc1 y_poll
    buffer_load_dword v17, v16, s[40:43], s34 offen
    s_add_u32 s34, s34, 8192
    s_waitcnt vmcnt(0)
    s_sleep 1
    ds_read_b32 v19, v18
    s_waitcnt lgkmcnt(0)
    v_readfirstlane_b32 s35, v19
    s_nop 0
    s_cmp_lg_u32 s35, 0
    s_cbranch_scc1 y_poll
    buffer_load_dword v17, v16, s[40:43], s34 offen
    s_add_u32 s34, s34, 8192
    s_waitcnt vmcnt(0)
    s_sleep 1
    ds_read_b32 v19, v18
    s_waitcnt lgkmcnt(0)
    v_readfirstlane_b32 s35, v19
    s_nop 0
    s_cmp_lg_u32 s35, 0
    s_cbranch_scc1 y_poll
    buffer_load_dword v17, v16, s[40:43], s34 offen
    s_add_u32 s34, s34, 8192
    s_waitcnt vmcnt(0)
    s_sleep 1
    ds_read_b32 v19, v18
    s_waitcnt lgkmcnt(0)
    v_readfirstlane_b32 s35, v19
    s_nop 0
    s_cmp_lg_u32 s35, 0
    s_cbranch_scc1 y_poll
    buffer_load_dword v17, v16, s[40:43], s34 offen
    s_add_u32 s34, s34, 8192
    s_waitcnt vmcnt(0)
    s_sleep 1
    ds_read_b32 v19, v18
    s_waitcnt lgkmcnt(0)
    v_readfirstlane_b32 s35, v19
    s_nop 0
    s_cmp_lg_u32 s35, 0
    s_cbranch_scc1 y_poll
    buffer_load_dword v17, v16, s[40:43], s34 offen
    s_add_u32 s34, s34, 8192
    s_waitcnt vmcnt(0)
y_poll:
    s_cmp_lg_u32 s15, 0
    s_cbranch_scc1 y_nopoll
    v_mov_b32 v16, 0
    v_mov_b32 v17, 1
    s_mov_b64 exec, 1
    buffer_atomic_add v17, v16, s[84:87], 0 offen sc1
    s_mov_b64 exec, -1
    s_mul_i32 s34, s12, 4864
    s_add_u32 s34, s34, 15990784
    v_lshlrev_b32 v16, 4, v2
    s_mov_b32 s30, 0
    s_mov_b64 s[40:41], 1023
pf_2:
    buffer_load_dwordx4 v[18:21], v16, s[8:11], s34 offen sc1
    s_add_u32 s30, s30, 1
    s_waitcnt vmcnt(0)
    v_xor_b32 v18, s80, v18
    v_xor_b32 v19, s80, v19
    v_xor_b32 v20, s80, v20
    v_xor_b32 v21, s80, v21
    v_or3_b32 v18, v18, v19, v20
    v_or_b32 v18, v18, v21
    v_cmp_ne_u32 vcc, 0, v18
    s_nop 0
    s_and_b64 vcc, vcc, s[40:41]
    s_cbranch_scc0 pf_2_d
    s_sleep 6
    s_cmp_lt_u32 s30, 200000
    s_cbranch_scc1 pf_2
pf_2_d:
    v_mov_b32 v18, 0
    v_mov_b32 v19, 1
    ds_write_b32 v18, v19
    s_waitcnt lgkmcnt(0)
y_nopoll:
    s_barrier
    s_and_b32 s18, s71, 1
    s_mul_i32 s18, s18, 10
    s_lshl_b32 s19, s13, 2
    s_add_u32 s18, s18, s19
    s_cmp_ge_u32 s18, 20
    s_cselect_b32 s3, 20, 0
    s_sub_u32 s18, s18, s3
    s_cmp_ge_u32 s18, 20
    s_cselect_b32 s3, 20, 0
    s_sub_u32 s18, s18, s3
    s_lshl_b32 s19, s18, 7
    s_lshl_b32 s18, s18, 10
    s_add_u32 m0, s33, 0
    s_nop 0
    buffer_load_dwordx4 v4, s[8:11], s18 offen offset:0 lds
    buffer_load_dwordx4 v5, s[8:11], s18 offen offset:1024 lds
    buffer_load_dwordx4 v6, s[8:11], s18 offen offset:2048 lds
    buffer_load_dwordx4 v7, s[8:11], s18 offen offset:3072 lds
    s_add_u32 s18, s18, 1024
    s_cmp_eq_u32 s18, 20480
    s_cselect_b32 s18, 0, s18
    s_add_u32 m0, s33, 16384
    s_cmp_ge_u32 s19, 1280
    s_cselect_b32 s40, s24, s36
    s_cselect_b32 s41, s25, s37
    s_cselect_b32 s32, 1280, 0
    s_sub_u32 s32, s19, s32
    buffer_load_dwordx4 v8, s[40:43], s32 offen offset:0 lds
    buffer_load_dwordx4 v9, s[40:43], s32 offen offset:1024 lds
    buffer_load_dwordx4 v10, s[40:43], s32 offen offset:2048 lds
    buffer_load_dwordx4 v11, s[40:43], s32 offen offset:3072 lds
    s_add_u32 s19, s19, 128
    s_cmp_eq_u32 s19, 2560
    s_cselect_b32 s19, 0, s19
    s_add_u32 m0, s33, 32768
    s_nop 0
    buffer_load_dwordx4 v4, s[8:11], s18 offen offset:0 lds
    buffer_load_dwordx4 v5, s[8:11], s18 offen offset:1024 lds
    buffer_load_dwordx4 v6, s[8:11], s18 offen offset:2048 lds
    buffer_load_dwordx4 v7, s[8:11], s18 offen offset:3072 lds
    s_add_u32 s18, s18, 1024
    s_cmp_eq_u32 s18, 20480
    s_cselect_b32 s18, 0, s18
    s_add_u32 m0, s33, 49152
    s_cmp_ge_u32 s19, 1280
    s_cselect_b32 s40, s24, s36
    s_cselect_b32 s41, s25, s37
    s_cselect_b32 s32, 1280, 0
    s_sub_u32 s32, s19, s32
    buffer_load_dwordx4 v8, s[40:43], s32 offen offset:0 lds
    buffer_load_dwordx4 v9, s[40:43], s32 offen offset:1024 lds
    buffer_load_dwordx4 v10, s[40:43], s32 offen offset:2048 lds
    buffer_load_dwordx4 v11, s[40:43], s32 offen offset:3072 lds
    s_add_u32 s19, s19, 128
    s_cmp_eq_u32 s19, 2560
    s_cselect_b32 s19, 0, s19
    s_add_u32 m0, s33, 65536
    s_nop 0
    buffer_load_dwordx4 v4, s[8:11], s18 offen offset:0 lds
    buffer_load_dwordx4 v5, s[8:11], s18 offen offset:1024 lds
    buffer_load_dwordx4 v6, s[8:11], s18 offen offset:2048 lds
    buffer_load_dwordx4 v7, s[8:11], s18 offen offset:3072 lds
    s_add_u32 s18, s18, 1024
    s_cmp_eq_u32 s18, 20480
    s_cselect_b32 s18, 0, s18
    s_waitcnt vmcnt(12)
    s_barrier
    s_waitcnt vmcnt(4)
    s_barrier
    s_add_u32 m0, s33, 0
    s_cmp_ge_u32 s19, 1280
    s_cselect_b32 s40, s24, s36
    s_cselect_b32 s41, s25, s37
    s_cselect_b32 s32, 1280, 0
    s_sub_u32 s32, s19, s32
    buffer_load_dwordx4 v8, s[40:43], s32 offen offset:0 lds
    buffer_load_dwordx4 v9, s[40:43], s32 offen offset:1024 lds
    buffer_load_dwordx4 v10, s[40:43], s32 offen offset:2048 lds
    buffer_load_dwordx4 v11, s[40:43], s32 offen offset:3072 lds
    s_add_u32 s19, s19, 128
    s_cmp_eq_u32 s19, 2560
    s_cselect_b32 s19, 0, s19
    s_add_u32 m0, s33, 16384
    s_nop 0
    buffer_load_dwordx4 v4, s[8:11], s18 offen offset:0 lds
    buffer_load_dwordx4 v5, s[8:11], s18 offen offset:1024 lds
    buffer_load_dwordx4 v6, s[8:11], s18 offen offset:2048 lds
    buffer_load_dwordx4 v7, s[8:11], s18 offen offset:3072 lds
    s_add_u32 s18, s18, 1024
    s_cmp_eq_u32 s18, 20480
    s_cselect_b32 s18, 0, s18
    s_waitcnt vmcnt(4)
    s_barrier
    s_add_u32 m0, s33, 32768
    s_cmp_ge_u32 s19, 1280
    s_cselect_b32 s40, s24, s36
    s_cselect_b32 s41, s25, s37
    s_cselect_b32 s32, 1280, 0
    s_sub_u32 s32, s19, s32
    buffer_load_dwordx4 v8, s[40:43], s32 offen offset:0 lds
    buffer_load_dwordx4 v9, s[40:43], s32 offen offset:1024 lds
    buffer_load_dwordx4 v10, s[40:43], s32 offen offset:2048 lds
    buffer_load_dwordx4 v11, s[40:43], s32 offen offset:3072 lds
    s_add_u32 s19, s19, 128
    s_cmp_eq_u32 s19, 2560
    s_cselect_b32 s19, 0, s19
    s_add_u32 m0, s33, 49152
    s_nop 0
    buffer_load_dwordx4 v4, s[8:11], s18 offen offset:0 lds
    buffer_load_dwordx4 v5, s[8:11], s18 offen offset:1024 lds
    buffer_load_dwordx4 v6, s[8:11], s18 offen offset:2048 lds
    buffer_load_dwordx4 v7, s[8:11], s18 offen offset:3072 lds
    s_add_u32 s18, s18, 1024
    s_cmp_eq_u32 s18, 20480
    s_cselect_b32 s18, 0, s18
    s_waitcnt vmcnt(4)
    s_barrier
    s_add_u32 m0, s33, 65536
    s_cmp_ge_u32 s19, 1280
    s_cselect_b32 s40, s24, s36
    s_cselect_b32 s41, s25, s37
    s_cselect_b32 s32, 1280, 0
    s_sub_u32 s32, s19, s32
    buffer_load_dwordx4 v8, s[40:43], s32 offen offset:0 lds
    buffer_load_dwordx4 v9, s[40:43], s32 offen offset:1024 lds
    buffer_load_dwordx4 v10, s[40:43], s32 offen offset:2048 lds
    buffer_load_dwordx4 v11, s[40:43], s32 offen offset:3072 lds
    s_add_u32 s19, s19, 128
    s_cmp_eq_u32 s19, 2560
    s_cselect_b32 s19, 0, s19
    s_add_u32 m0, s33, 0
    s_nop 0
    buffer_load_dwordx4 v4, s[8:11], s18 offen offset:0 lds
    buffer_load_dwordx4 v5, s[8:11], s18 offen offset:1024 lds
    buffer_load_dwordx4 v6, s[8:11], s18 offen offset:2048 lds
    buffer_load_dwordx4 v7, s[8:11], s18 offen offset:3072 lds
    s_add_u32 s18, s18, 1024
    s_cmp_eq_u32 s18, 20480
    s_cselect_b32 s18, 0, s18
    s_waitcnt vmcnt(4)
    s_barrier
    s_add_u32 m0, s33, 16384
    s_cmp_ge_u32 s19, 1280
    s_cselect_b32 s40, s24, s36
    s_cselect_b32 s41, s25, s37
    s_cselect_b32 s32, 1280, 0
    s_sub_u32 s32, s19, s32
    buffer_load_dwordx4 v8, s[40:43], s32 offen offset:0 lds
    buffer_load_dwordx4 v9, s[40:43], s32 offen offset:1024 lds
    buffer_load_dwordx4 v10, s[40:43], s32 offen offset:2048 lds
    buffer_load_dwordx4 v11, s[40:43], s32 offen offset:3072 lds
    s_add_u32 s19, s19, 128
    s_cmp_eq_u32 s19, 2560
    s_cselect_b32 s19, 0, s19
    s_add_u32 m0, s33, 32768
    s_nop 0
    buffer_load_dwordx4 v4, s[8:11], s18 offen offset:0 lds
    buffer_load_dwordx4 v5, s[8:11], s18 offen offset:1024 lds
    buffer_load_dwordx4 v6, s[8:11], s18 offen offset:2048 lds
    buffer_load_dwordx4 v7, s[8:11], s18 offen offset:3072 lds
    s_add_u32 s18, s18, 1024
    s_cmp_eq_u32 s18, 20480
    s_cselect_b32 s18, 0, s18
    s_waitcnt vmcnt(4)
    s_barrier
    s_add_u32 m0, s33, 49152
    s_cmp_ge_u32 s19, 1280
    s_cselect_b32 s40, s24, s36
    s_cselect_b32 s41, s25, s37
    s_cselect_b32 s32, 1280, 0
    s_sub_u32 s32, s19, s32
    buffer_load_dwordx4 v8, s[40:43], s32 offen offset:0 lds
    buffer_load_dwordx4 v9, s[40:43], s32 offen offset:1024 lds
    buffer_load_dwordx4 v10, s[40:43], s32 offen offset:2048 lds
    buffer_load_dwordx4 v11, s[40:43], s32 offen offset:3072 lds
    s_add_u32 s19, s19, 128
    s_cmp_eq_u32 s19, 2560
    s_cselect_b32 s19, 0, s19
    s_add_u32 m0, s33, 65536
    s_nop 0
    buffer_load_dwordx4 v4, s[8:11], s18 offen offset:0 lds
    buffer_load_dwordx4 v5, s[8:11], s18 offen offset:1024 lds
    buffer_load_dwordx4 v6, s[8:11], s18 offen offset:2048 lds
    buffer_load_dwordx4 v7, s[8:11], s18 offen offset:3072 lds
    s_add_u32 s18, s18, 1024
    s_cmp_eq_u32 s18, 20480
    s_cselect_b32 s18, 0, s18
    s_waitcnt vmcnt(4)
    s_barrier
    s_add_u32 m0, s33, 0
    s_cmp_ge_u32 s19, 1280
    s_cselect_b32 s40, s24, s36
    s_cselect_b32 s41, s25, s37
    s_cselect_b32 s32, 1280, 0
    s_sub_u32 s32, s19, s32
    buffer_load_dwordx4 v8, s[40:43], s32 offen offset:0 lds
    buffer_load_dwordx4 v9, s[40:43], s32 offen offset:1024 lds
    buffer_load_dwordx4 v10, s[40:43], s32 offen offset:2048 lds
    buffer_load_dwordx4 v11, s[40:43], s32 offen offset:3072 lds
    s_add_u32 s19, s19, 128
    s_cmp_eq_u32 s19, 2560
    s_cselect_b32 s19, 0, s19
    s_add_u32 m0, s33, 16384
    s_nop 0
    buffer_load_dwordx4 v4, s[8:11], s18 offen offset:0 lds
    buffer_load_dwordx4 v5, s[8:11], s18 offen offset:1024 lds
    buffer_load_dwordx4 v6, s[8:11], s18 offen offset:2048 lds
    buffer_load_dwordx4 v7, s[8:11], s18 offen offset:3072 lds
    s_add_u32 s18, s18, 1024
    s_cmp_eq_u32 s18, 20480
    s_cselect_b32 s18, 0, s18
    s_waitcnt vmcnt(4)
    s_barrier
    s_add_u32 m0, s33, 32768
    s_cmp_ge_u32 s19, 1280
    s_cselect_b32 s40, s24, s36
    s_cselect_b32 s41, s25, s37
    s_cselect_b32 s32, 1280, 0
    s_sub_u32 s32, s19, s32
    buffer_load_dwordx4 v8, s[40:43], s32 offen offset:0 lds
    buffer_load_dwordx4 v9, s[40:43], s32 offen offset:1024 lds
    buffer_load_dwordx4 v10, s[40:43], s32 offen offset:2048 lds
    buffer_load_dwordx4 v11, s[40:43], s32 offen offset:3072 lds
    s_add_u32 s19, s19, 128
    s_cmp_eq_u32 s19, 2560
    s_cselect_b32 s19, 0, s19
    s_add_u32 m0, s33, 49152
    s_nop 0
    buffer_load_dwordx4 v4, s[8:11], s18 offen offset:0 lds
    buffer_load_dwordx4 v5, s[8:11], s18 offen offset:1024 lds
    buffer_load_dwordx4 v6, s[8:11], s18 offen offset:2048 lds
    buffer_load_dwordx4 v7, s[8:11], s18 offen offset:3072 lds
    s_add_u32 s18, s18, 1024
    s_cmp_eq_u32 s18, 20480
    s_cselect_b32 s18, 0, s18
    s_waitcnt vmcnt(4)
    s_barrier
    s_add_u32 m0, s33, 65536
    s_cmp_ge_u32 s19, 1280
    s_cselect_b32 s40, s24, s36
    s_cselect_b32 s41, s25, s37
    s_cselect_b32 s32, 1280, 0
    s_sub_u32 s32, s19, s32
    buffer_load_dwordx4 v8, s[40:43], s32 offen offset:0 lds
    buffer_load_dwordx4 v9, s[40:43], s32 offen offset:1024 lds
    buffer_load_dwordx4 v10, s[40:43], s32 offen offset:2048 lds
    buffer_load_dwordx4 v11, s[40:43], s32 offen offset:3072 lds
    s_add_u32 s19, s19, 128
    s_cmp_eq_u32 s19, 2560
    s_cselect_b32 s19, 0, s19
    s_add_u32 m0, s33, 0
    s_nop 0
    buffer_load_dwordx4 v4, s[8:11], s18 offen offset:0 lds
    buffer_load_dwordx4 v5, s[8:11], s18 offen offset:1024 lds
    buffer_load_dwordx4 v6, s[8:11], s18 offen offset:2048 lds
    buffer_load_dwordx4 v7, s[8:11], s18 offen offset:3072 lds
    s_add_u32 s18, s18, 1024
    s_cmp_eq_u32 s18, 20480
    s_cselect_b32 s18, 0, s18
    s_waitcnt vmcnt(4)
    s_barrier
    s_add_u32 m0, s33, 16384
    s_cmp_ge_u32 s19, 1280
    s_cselect_b32 s40, s24, s36
    s_cselect_b32 s41, s25, s37
    s_cselect_b32 s32, 1280, 0
    s_sub_u32 s32, s19, s32
    buffer_load_dwordx4 v8, s[40:43], s32 offen offset:0 lds
    buffer_load_dwordx4 v9, s[40:43], s32 offen offset:1024 lds
    buffer_load_dwordx4 v10, s[40:43], s32 offen offset:2048 lds
    buffer_load_dwordx4 v11, s[40:43], s32 offen offset:3072 lds
    s_add_u32 s19, s19, 128
    s_cmp_eq_u32 s19, 2560
    s_cselect_b32 s19, 0, s19
    s_add_u32 m0, s33, 32768
    s_nop 0
    buffer_load_dwordx4 v4, s[8:11], s18 offen offset:0 lds
    buffer_load_dwordx4 v5, s[8:11], s18 offen offset:1024 lds
    buffer_load_dwordx4 v6, s[8:11], s18 offen offset:2048 lds
    buffer_load_dwordx4 v7, s[8:11], s18 offen offset:3072 lds
    s_add_u32 s18, s18, 1024
    s_cmp_eq_u32 s18, 20480
    s_cselect_b32 s18, 0, s18
    s_waitcnt vmcnt(4)
    s_barrier
    s_add_u32 m0, s33, 49152
    s_cmp_ge_u32 s19, 1280
    s_cselect_b32 s40, s24, s36
    s_cselect_b32 s41, s25, s37
    s_cselect_b32 s32, 1280, 0
    s_sub_u32 s32, s19, s32
    buffer_load_dwordx4 v8, s[40:43], s32 offen offset:0 lds
    buffer_load_dwordx4 v9, s[40:43], s32 offen offset:1024 lds
    buffer_load_dwordx4 v10, s[40:43], s32 offen offset:2048 lds
    buffer_load_dwordx4 v11, s[40:43], s32 offen offset:3072 lds
    s_add_u32 s19, s19, 128
    s_cmp_eq_u32 s19, 2560
    s_cselect_b32 s19, 0, s19
    s_add_u32 m0, s33, 65536
    s_nop 0
    buffer_load_dwordx4 v4, s[8:11], s18 offen offset:0 lds
    buffer_load_dwordx4 v5, s[8:11], s18 offen offset:1024 lds
    buffer_load_dwordx4 v6, s[8:11], s18 offen offset:2048 lds
    buffer_load_dwordx4 v7, s[8:11], s18 offen offset:3072 lds
    s_add_u32 s18, s18, 1024
    s_cmp_eq_u32 s18, 20480
    s_cselect_b32 s18, 0, s18
    s_waitcnt vmcnt(4)
    s_barrier
    s_add_u32 m0, s33, 0
    s_cmp_ge_u32 s19, 1280
    s_cselect_b32 s40, s24, s36
    s_cselect_b32 s41, s25, s37
    s_cselect_b32 s32, 1280, 0
    s_sub_u32 s32, s19, s32
    buffer_load_dwordx4 v8, s[40:43], s32 offen offset:0 lds
    buffer_load_dwordx4 v9, s[40:43], s32 offen offset:1024 lds
    buffer_load_dwordx4 v10, s[40:43], s32 offen offset:2048 lds
    buffer_load_dwordx4 v11, s[40:43], s32 offen offset:3072 lds
    s_add_u32 s19, s19, 128
    s_cmp_eq_u32 s19, 2560
    s_cselect_b32 s19, 0, s19
    s_add_u32 m0, s33, 16384
    s_nop 0
    buffer_load_dwordx4 v4, s[8:11], s18 offen offset:0 lds
    buffer_load_dwordx4 v5, s[8:11], s18 offen offset:1024 lds
    buffer_load_dwordx4 v6, s[8:11], s18 offen offset:2048 lds
    buffer_load_dwordx4 v7, s[8:11], s18 offen offset:3072 lds
    s_add_u32 s18, s18, 1024
    s_cmp_eq_u32 s18, 20480
    s_cselect_b32 s18, 0, s18
    s_waitcnt vmcnt(4)
    s_barrier
    s_add_u32 m0, s33, 32768
    s_cmp_ge_u32 s19, 1280
    s_cselect_b32 s40, s24, s36
    s_cselect_b32 s41, s25, s37
    s_cselect_b32 s32, 1280, 0
    s_sub_u32 s32, s19, s32
    buffer_load_dwordx4 v8, s[40:43], s32 offen offset:0 lds
    buffer_load_dwordx4 v9, s[40:43], s32 offen offset:1024 lds
    buffer_load_dwordx4 v10, s[40:43], s32 offen offset:2048 lds
    buffer_load_dwordx4 v11, s[40:43], s32 offen offset:3072 lds
    s_add_u32 s19, s19, 128
    s_cmp_eq_u32 s19, 2560
    s_cselect_b32 s19, 0, s19
    s_add_u32 m0, s33, 49152
    s_nop 0
    buffer_load_dwordx4 v4, s[8:11], s18 offen offset:0 lds
    buffer_load_dwordx4 v5, s[8:11], s18 offen offset:1024 lds
    buffer_load_dwordx4 v6, s[8:11], s18 offen offset:2048 lds
    buffer_load_dwordx4 v7, s[8:11], s18 offen offset:3072 lds
    s_add_u32 s18, s18, 1024
    s_cmp_eq_u32 s18, 20480
    s_cselect_b32 s18, 0, s18
    s_waitcnt vmcnt(4)
    s_barrier
    s_add_u32 m0, s33, 65536
    s_cmp_ge_u32 s19, 1280
    s_cselect_b32 s40, s24, s36
    s_cselect_b32 s41, s25, s37
    s_cselect_b32 s32, 1280, 0
    s_sub_u32 s32, s19, s32
    buffer_load_dwordx4 v8, s[40:43], s32 offen offset:0 lds
    buffer_load_dwordx4 v9, s[40:43], s32 offen offset:1024 lds
    buffer_load_dwordx4 v10, s[40:43], s32 offen offset:2048 lds
    buffer_load_dwordx4 v11, s[40:43], s32 offen offset:3072 lds
    s_add_u32 s19, s19, 128
    s_cmp_eq_u32 s19, 2560
    s_cselect_b32 s19, 0, s19
    s_add_u32 m0, s33, 0
    s_nop 0
    buffer_load_dwordx4 v4, s[8:11], s18 offen offset:0 lds
    buffer_load_dwordx4 v5, s[8:11], s18 offen offset:1024 lds
    buffer_load_dwordx4 v6, s[8:11], s18 offen offset:2048 lds
    buffer_load_dwordx4 v7, s[8:11], s18 offen offset:3072 lds
    s_add_u32 s18, s18, 1024
    s_cmp_eq_u32 s18, 20480
    s_cselect_b32 s18, 0, s18
    s_waitcnt vmcnt(4)
    s_barrier
    s_add_u32 m0, s33, 16384
    s_cmp_ge_u32 s19, 1280
    s_cselect_b32 s40, s24, s36
    s_cselect_b32 s41, s25, s37
    s_cselect_b32 s32, 1280, 0
    s_sub_u32 s32, s19, s32
    buffer_load_dwordx4 v8, s[40:43], s32 offen offset:0 lds
    buffer_load_dwordx4 v9, s[40:43], s32 offen offset:1024 lds
    buffer_load_dwordx4 v10, s[40:43], s32 offen offset:2048 lds
    buffer_load_dwordx4 v11, s[40:43], s32 offen offset:3072 lds
    s_add_u32 s19, s19, 128
    s_cmp_eq_u32 s19, 2560
    s_cselect_b32 s19, 0, s19
    s_add_u32 m0, s33, 32768
    s_nop 0
    buffer_load_dwordx4 v4, s[8:11], s18 offen offset:0 lds
    buffer_load_dwordx4 v5, s[8:11], s18 offen offset:1024 lds
    buffer_load_dwordx4 v6, s[8:11], s18 offen offset:2048 lds
    buffer_load_dwordx4 v7, s[8:11], s18 offen offset:3072 lds
    s_add_u32 s18, s18, 1024
    s_cmp_eq_u32 s18, 20480
    s_cselect_b32 s18, 0, s18
    s_waitcnt vmcnt(4)
    s_barrier
    s_add_u32 m0, s33, 49152
    s_cmp_ge_u32 s19, 1280
    s_cselect_b32 s40, s24, s36
    s_cselect_b32 s41, s25, s37
    s_cselect_b32 s32, 1280, 0
    s_sub_u32 s32, s19, s32
    buffer_load_dwordx4 v8, s[40:43], s32 offen offset:0 lds
    buffer_load_dwordx4 v9, s[40:43], s32 offen offset:1024 lds
    buffer_load_dwordx4 v10, s[40:43], s32 offen offset:2048 lds
    buffer_load_dwordx4 v11, s[40:43], s32 offen offset:3072 lds
    s_add_u32 s19, s19, 128
    s_cmp_eq_u32 s19, 2560
    s_cselect_b32 s19, 0, s19
    s_add_u32 m0, s33, 65536
    s_nop 0
    buffer_load_dwordx4 v4, s[8:11], s18 offen offset:0 lds
    buffer_load_dwordx4 v5, s[8:11], s18 offen offset:1024 lds
    buffer_load_dwordx4 v6, s[8:11], s18 offen offset:2048 lds
    buffer_load_dwordx4 v7, s[8:11], s18 offen offset:3072 lds
    s_add_u32 s18, s18, 1024
    s_cmp_eq_u32 s18, 20480
    s_cselect_b32 s18, 0, s18
    s_waitcnt vmcnt(4)
    s_barrier
    s_add_u32 m0, s33, 0
    s_cmp_ge_u32 s19, 1280
    s_cselect_b32 s40, s24, s36
    s_cselect_b32 s41, s25, s37
    s_cselect_b32 s32, 1280, 0
    s_sub_u32 s32, s19, s32
    buffer_load_dwordx4 v8, s[40:43], s32 offen offset:0 lds
    buffer_load_dwordx4 v9, s[40:43], s32 offen offset:1024 lds
    buffer_load_dwordx4 v10, s[40:43], s32 offen offset:2048 lds
    buffer_load_dwordx4 v11, s[40:43], s32 offen offset:3072 lds
    s_add_u32 s19, s19, 128
    s_cmp_eq_u32 s19, 2560
    s_cselect_b32 s19, 0, s19
    s_add_u32 m0, s33, 16384
    s_nop 0
    buffer_load_dwordx4 v4, s[8:11], s18 offen offset:0 lds
    buffer_load_dwordx4 v5, s[8:11], s18 offen offset:1024 lds
    buffer_load_dwordx4 v6, s[8:11], s18 offen offset:2048 lds
    buffer_load_dwordx4 v7, s[8:11], s18 offen offset:3072 lds
    s_add_u32 s18, s18, 1024
    s_cmp_eq_u32 s18, 20480
    s_cselect_b32 s18, 0, s18
    s_waitcnt vmcnt(4)
    s_barrier
    s_add_u32 m0, s33, 32768
    s_cmp_ge_u32 s19, 1280
    s_cselect_b32 s40, s24, s36
    s_cselect_b32 s41, s25, s37
    s_cselect_b32 s32, 1280, 0
    s_sub_u32 s32, s19, s32
    buffer_load_dwordx4 v8, s[40:43], s32 offen offset:0 lds
    buffer_load_dwordx4 v9, s[40:43], s32 offen offset:1024 lds
    buffer_load_dwordx4 v10, s[40:43], s32 offen offset:2048 lds
    buffer_load_dwordx4 v11, s[40:43], s32 offen offset:3072 lds
    s_add_u32 s19, s19, 128
    s_cmp_eq_u32 s19, 2560
    s_cselect_b32 s19, 0, s19
    s_add_u32 m0, s33, 49152
    s_nop 0
    buffer_load_dwordx4 v4, s[8:11], s18 offen offset:0 lds
    buffer_load_dwordx4 v5, s[8:11], s18 offen offset:1024 lds
    buffer_load_dwordx4 v6, s[8:11], s18 offen offset:2048 lds
    buffer_load_dwordx4 v7, s[8:11], s18 offen offset:3072 lds
    s_add_u32 s18, s18, 1024
    s_cmp_eq_u32 s18, 20480
    s_cselect_b32 s18, 0, s18
    s_waitcnt vmcnt(4)
    s_barrier
    s_add_u32 m0, s33, 65536
    s_cmp_ge_u32 s19, 1280
    s_cselect_b32 s40, s24, s36
    s_cselect_b32 s41, s25, s37
    s_cselect_b32 s32, 1280, 0
    s_sub_u32 s32, s19, s32
    buffer_load_dwordx4 v8, s[40:43], s32 offen offset:0 lds
    buffer_load_dwordx4 v9, s[40:43], s32 offen offset:1024 lds
    buffer_load_dwordx4 v10, s[40:43], s32 offen offset:2048 lds
    buffer_load_dwordx4 v11, s[40:43], s32 offen offset:3072 lds
    s_add_u32 s19, s19, 128
    s_cmp_eq_u32 s19, 2560
    s_cselect_b32 s19, 0, s19
    s_waitcnt vmcnt(0)
    s_barrier
    s_barrier
    buffer_load_dwordx2 v[20:21], v117, s[76:79], 0 offen
    s_mov_b32 s33, 2560
    buffer_load_dwordx2 v[22:23], v117, s[76:79], s33 offen
    s_mov_b32 s33, 5120
    buffer_load_dwordx2 v[24:25], v117, s[76:79], s33 offen
    s_mov_b32 s33, 7680
    buffer_load_dwordx2 v[26:27], v117, s[76:79], s33 offen
    s_mov_b32 s33, 10240
    buffer_load_dwordx2 v[28:29], v117, s[76:79], s33 offen
    s_mov_b32 s33, 12800
    buffer_load_dwordx2 v[30:31], v117, s[76:79], s33 offen
    s_mov_b32 s33, 15360
    buffer_load_dwordx2 v[32:33], v117, s[76:79], s33 offen
    s_mov_b32 s33, 17920
    buffer_load_dwordx2 v[34:35], v117, s[76:79], s33 offen
    s_barrier
    ds_read_b128 v[52:55], v116 offset:0
    ds_read_b128 v[56:59], v116 offset:1056
    ds_read_b128 v[60:63], v116 offset:2112
    ds_read_b128 v[64:67], v116 offset:3168
    ds_read_b128 v[68:71], v116 offset:4224
    ds_read_b128 v[72:75], v116 offset:5280
    ds_read_b128 v[76:79], v116 offset:6336
    ds_read_b128 v[80:83], v116 offset:7392
    s_mov_b32 s33, 0
    s_waitcnt vmcnt(7) lgkmcnt(7)
    v_lshlrev_b32 v5, 16, v20
    v_and_b32 v6, 0xffff0000, v20
    v_fmac_f32 v52, v5, v120
    v_fmac_f32 v53, v6, v121
    v_lshlrev_b32 v5, 16, v21
    v_and_b32 v6, 0xffff0000, v21
    v_fmac_f32 v54, v5, v122
    v_fmac_f32 v55, v6, v123
    buffer_store_dwordx4 v[52:55], v118, s[92:95], s33 offen sc1 nt
    s_add_u32 s33, s33, 10240
    s_waitcnt vmcnt(7) lgkmcnt(6)
    v_lshlrev_b32 v5, 16, v22
    v_and_b32 v6, 0xffff0000, v22
    v_fmac_f32 v56, v5, v120
    v_fmac_f32 v57, v6, v121
    v_lshlrev_b32 v5, 16, v23
    v_and_b32 v6, 0xffff0000, v23
    v_fmac_f32 v58, v5, v122
    v_fmac_f32 v59, v6, v123
    buffer_store_dwordx4 v[56:59], v118, s[92:95], s33 offen sc1 nt
    s_add_u32 s33, s33, 10240
    s_waitcnt vmcnt(7) lgkmcnt(5)
    v_lshlrev_b32 v5, 16, v24
    v_and_b32 v6, 0xffff0000, v24
    v_fmac_f32 v60, v5, v120
    v_fmac_f32 v61, v6, v121
    v_lshlrev_b32 v5, 16, v25
    v_and_b32 v6, 0xffff0000, v25
    v_fmac_f32 v62, v5, v122
    v_fmac_f32 v63, v6, v123
    buffer_store_dwordx4 v[60:63], v118, s[92:95], s33 offen sc1 nt
    s_add_u32 s33, s33, 10240
    s_waitcnt vmcnt(7) lgkmcnt(4)
    v_lshlrev_b32 v5, 16, v26
    v_and_b32 v6, 0xffff0000, v26
    v_fmac_f32 v64, v5, v120
    v_fmac_f32 v65, v6, v121
    v_lshlrev_b32 v5, 16, v27
    v_and_b32 v6, 0xffff0000, v27
    v_fmac_f32 v66, v5, v122
    v_fmac_f32 v67, v6, v123
    buffer_store_dwordx4 v[64:67], v118, s[92:95], s33 offen sc1 nt
    s_add_u32 s33, s33, 10240
    s_waitcnt vmcnt(7) lgkmcnt(3)
    v_lshlrev_b32 v5, 16, v28
    v_and_b32 v6, 0xffff0000, v28
    v_fmac_f32 v68, v5, v120
    v_fmac_f32 v69, v6, v121
    v_lshlrev_b32 v5, 16, v29
    v_and_b32 v6, 0xffff0000, v29
    v_fmac_f32 v70, v5, v122
    v_fmac_f32 v71, v6, v123
    buffer_store_dwordx4 v[68:71], v118, s[92:95], s33 offen sc1 nt
    s_add_u32 s33, s33, 10240
    s_waitcnt vmcnt(7) lgkmcnt(2)
    v_lshlrev_b32 v5, 16, v30
    v_and_b32 v6, 0xffff0000, v30
    v_fmac_f32 v72, v5, v120
    v_fmac_f32 v73, v6, v121
    v_lshlrev_b32 v5, 16, v31
    v_and_b32 v6, 0xffff0000, v31
    v_fmac_f32 v74, v5, v122
    v_fmac_f32 v75, v6, v123
    buffer_store_dwordx4 v[72:75], v118, s[92:95], s33 offen sc1 nt
    s_add_u32 s33, s33, 10240
    s_waitcnt vmcnt(7) lgkmcnt(1)
    v_lshlrev_b32 v5, 16, v32
    v_and_b32 v6, 0xffff0000, v32
    v_fmac_f32 v76, v5, v120
    v_fmac_f32 v77, v6, v121
    v_lshlrev_b32 v5, 16, v33
    v_and_b32 v6, 0xffff0000, v33
    v_fmac_f32 v78, v5, v122
    v_fmac_f32 v79, v6, v123
    buffer_store_dwordx4 v[76:79], v118, s[92:95], s33 offen sc1 nt
    s_add_u32 s33, s33, 10240
    s_waitcnt vmcnt(7) lgkmcnt(0)
    v_lshlrev_b32 v5, 16, v34
    v_and_b32 v6, 0xffff0000, v34
    v_fmac_f32 v80, v5, v120
    v_fmac_f32 v81, v6, v121
    v_lshlrev_b32 v5, 16, v35
    v_and_b32 v6, 0xffff0000, v35
    v_fmac_f32 v82, v5, v122
    v_fmac_f32 v83, v6, v123
    buffer_store_dwordx4 v[80:83], v118, s[92:95], s33 offen sc1 nt
    s_endpgm
c_bu:
    s_load_dwordx4 s[24:27], s[0:1], 8
    s_load_dwordx2 s[16:17], s[0:1], 56
    s_sub_u32 s30, s71, 12
    s_and_b32 s12, s70, 3
    s_lshl_b32 s12, s12, 2
    s_and_b32 s13, s30, 3
    s_add_u32 s12, s12, s13
    s_lshr_b32 s13, s70, 2
    s_mul_i32 s13, s13, 5
    s_lshr_b32 s31, s30, 2
    s_add_u32 s13, s13, s31
    s_lshl_b32 s34, s13, 6
    s_lshl_b32 s35, s29, 5
    s_add_u32 s34, s34, s35
    v_and_b32 v124, 31, v2
    v_add_u32 v124, s34, v124
    v_lshrrev_b32 v125, 5, v2
    v_lshlrev_b32 v28, 1, v124
    s_waitcnt lgkmcnt(0)
    global_load_ushort v116, v28, s[24:25]
    global_load_ushort v117, v28, s[26:27]
    global_load_ushort v118, v28, s[16:17]
    s_waitcnt lgkmcnt(0)
    s_add_u32 s6, s4, 12517376
    s_addc_u32 s7, s5, 0
    s_load_dword s80, s[6:7], 0
    s_mov_b32 s8, s4
    s_and_b32 s9, s5, 0xffff
    s_mov_b32 s10, 0x1600000
    s_mov_b32 s11, 0x00020000
    s_mov_b32 s92, s88
    s_and_b32 s93, s89, 0xffff
    s_mov_b32 s94, 0xa00000
    s_mov_b32 s95, 0x00020000
    s_mov_b32 s84, s90
    s_and_b32 s85, s91, 0xffff
    s_mov_b32 s86, 0x100
    s_mov_b32 s87, 0x00020000
    v_and_b32 v20, 31, v2
    v_lshrrev_b32 v21, 5, v2
    v_bfe_u32 v22, v2, 1, 3
    v_xor_b32 v21, v21, v22
    v_lshlrev_b32 v21, 4, v21
    v_lshl_add_u32 v20, v20, 7, v21
    s_mul_i32 s32, s28, 8192
    v_add_u32 v4, s32, v20
    v_xor_b32 v5, 32, v4
    v_xor_b32 v6, 64, v4
    v_xor_b32 v7, 96, v4
    v_and_b32 v20, 31, v2
    v_lshrrev_b32 v21, 5, v2
    v_bfe_u32 v22, v2, 1, 3
    v_xor_b32 v21, v21, v22
    v_lshlrev_b32 v21, 4, v21
    v_lshl_add_u32 v20, v20, 7, v21
    s_mul_i32 s32, s29, 8192
    v_add_u32 v8, s32, v20
    v_xor_b32 v9, 32, v8
    v_xor_b32 v10, 64, v8
    v_xor_b32 v11, 96, v8
    v_add_u32 v12, 49152, v4
    v_add_u32 v13, 49152, v5
    v_add_u32 v14, 49152, v6
    v_add_u32 v15, 49152, v7
    v_add_u32 v16, 49152, v8
    v_add_u32 v17, 49152, v9
    v_add_u32 v18, 49152, v10
    v_add_u32 v19, 49152, v11
    v_mov_b32 v52, 0
    v_mov_b32 v53, 0
    v_mov_b32 v54, 0
    v_mov_b32 v55, 0
    v_mov_b32 v56, 0
    v_mov_b32 v57, 0
    v_mov_b32 v58, 0
    v_mov_b32 v59, 0
    v_mov_b32 v60, 0
    v_mov_b32 v61, 0
    v_mov_b32 v62, 0
    v_mov_b32 v63, 0
    v_mov_b32 v64, 0
    v_mov_b32 v65, 0
    v_mov_b32 v66, 0
    v_mov_b32 v67, 0
    v_mov_b32 v68, 0
    v_mov_b32 v69, 0
    v_mov_b32 v70, 0
    v_mov_b32 v71, 0
    v_mov_b32 v72, 0
    v_mov_b32 v73, 0
    v_mov_b32 v74, 0
    v_mov_b32 v75, 0
    v_mov_b32 v76, 0
    v_mov_b32 v77, 0
    v_mov_b32 v78, 0
    v_mov_b32 v79, 0
    v_mov_b32 v80, 0
    v_mov_b32 v81, 0
    v_mov_b32 v82, 0
    v_mov_b32 v83, 0
    v_mov_b32 v84, 0
    v_mov_b32 v85, 0
    v_mov_b32 v86, 0
    v_mov_b32 v87, 0
    v_mov_b32 v88, 0
    v_mov_b32 v89, 0
    v_mov_b32 v90, 0
    v_mov_b32 v91, 0
    v_mov_b32 v92, 0
    v_mov_b32 v93, 0
    v_mov_b32 v94, 0
    v_mov_b32 v95, 0
    v_mov_b32 v96, 0
    v_mov_b32 v97, 0
    v_mov_b32 v98, 0
    v_mov_b32 v99, 0
    v_mov_b32 v100, 0
    v_mov_b32 v101, 0
    v_mov_b32 v102, 0
    v_mov_b32 v103, 0
    v_mov_b32 v104, 0
    v_mov_b32 v105, 0
    v_mov_b32 v106, 0
    v_mov_b32 v107, 0
    v_mov_b32 v108, 0
    v_mov_b32 v109, 0
    v_mov_b32 v110, 0
    v_mov_b32 v111, 0
    v_mov_b32 v112, 0
    v_mov_b32 v113, 0
    v_mov_b32 v114, 0
    v_mov_b32 v115, 0
    s_mov_b32 s32, 0x3fb8aa3b
    s_mov_b32 s33, 0x3e22f983
    s_waitcnt vmcnt(0)
    v_lshlrev_b32 v29, 16, v116
    v_lshlrev_b32 v30, 16, v117
    v_lshlrev_b32 v31, 16, v118
    v_mul_f32 v31, s32, v31
    v_exp_f32 v31, v31
    s_nop 0
    v_cvt_pk_bf16_f32 v31, v31, v31
    v_lshlrev_b32 v31, 16, v31
    v_mul_f32 v20, v31, v29
    v_mul_f32 v21, v31, v30
    v_mul_f32 v20, s32, v20
    v_mul_f32 v21, s33, v21
    v_exp_f32 v20, v20
    v_fract_f32 v21, v21
    v_cos_f32 v22, v21
    v_sin_f32 v23, v21
    v_mul_f32 v116, v20, v22
    v_mul_f32 v117, v20, v23
    v_add_f32 v24, -1.0, v116
    v_mul_f32 v25, v29, v29
    v_fma_f32 v25, v30, v30, v25
    v_rcp_f32 v25, v25
    v_mul_f32 v118, v24, v29
    v_add_f32 v25, v25, v25
    v_fma_f32 v118, v117, v30, v118
    v_mul_f32 v119, v117, v29
    v_fma_f32 v119, -v24, v30, v119
    v_mul_f32 v118, v118, v25
    v_mul_f32 v119, v119, v25
    v_mul_f32 v20, v116, v116
    v_mul_f32 v21, v116, v117
    v_fma_f32 v20, -v117, v117, v20
    v_fma_f32 v121, v117, v116, v21
    v_mov_b32 v120, v20
    v_mul_f32 v20, v120, v120
    v_mul_f32 v21, v120, v121
    v_fma_f32 v20, -v121, v121, v20
    v_fma_f32 v121, v121, v120, v21
    v_mov_b32 v120, v20
    v_mul_f32 v20, v120, v120
    v_mul_f32 v21, v120, v121
    v_fma_f32 v20, -v121, v121, v20
    v_fma_f32 v121, v121, v120, v21
    v_mov_b32 v120, v20
    v_mul_f32 v20, v120, v120
    v_mul_f32 v21, v120, v121
    v_fma_f32 v20, -v121, v121, v20
    v_fma_f32 v121, v121, v120, v21
    v_mov_b32 v120, v20
    v_mul_f32 v20, v120, v120
    v_mul_f32 v21, v120, v121
    v_fma_f32 v20, -v121, v121, v20
    v_fma_f32 v121, v121, v120, v21
    v_mov_b32 v120, v20
    v_mul_f32 v20, v120, v120
    v_mul_f32 v21, v120, v121
    v_fma_f32 v20, -v121, v121, v20
    v_fma_f32 v123, v121, v120, v21
    v_mov_b32 v122, v20
    s_waitcnt lgkmcnt(0)
    s_add_u32 s80, s80, 1
    s_setprio 0
    s_barrier
    ds_read_b128 v[28:31], v8 offset:16384
    ds_read_b128 v[20:23], v4 offset:0
    ds_read_b128 v[24:27], v4 offset:4096
    ds_read_b128 v[32:35], v8 offset:20480
    ds_read_b128 v[44:47], v9 offset:16384
    ds_read_b128 v[36:39], v5 offset:0
    ds_read_b128 v[40:43], v5 offset:4096
    ds_read_b128 v[48:51], v9 offset:20480
    s_waitcnt lgkmcnt(0)
    s_mov_b32 s32, 0
.p2align 3
b_loop:
    s_waitcnt lgkmcnt(6)
    v_mfma_f32_32x32x16_bf16 v[52:67], v[20:23], v[28:31], v[52:67]
    s_waitcnt lgkmcnt(5)
    v_mfma_f32_32x32x16_bf16 v[68:83], v[24:27], v[28:31], v[68:83]
    ds_read_b128 v[28:31], v10 offset:16384
    s_waitcnt lgkmcnt(5)
    v_mfma_f32_32x32x16_bf16 v[84:99], v[20:23], v[32:35], v[84:99]
    ds_read_b128 v[20:23], v6 offset:0
    v_mfma_f32_32x32x16_bf16 v[100:115], v[24:27], v[32:35], v[100:115]
    ds_read_b128 v[24:27], v6 offset:4096
    ds_read_b128 v[32:35], v10 offset:20480
    s_waitcnt lgkmcnt(6)
    v_mfma_f32_32x32x16_bf16 v[52:67], v[36:39], v[44:47], v[52:67]
    s_waitcnt lgkmcnt(5)
    v_mfma_f32_32x32x16_bf16 v[68:83], v[40:43], v[44:47], v[68:83]
    ds_read_b128 v[44:47], v11 offset:16384
    s_waitcnt lgkmcnt(5)
    v_mfma_f32_32x32x16_bf16 v[84:99], v[36:39], v[48:51], v[84:99]
    ds_read_b128 v[36:39], v7 offset:0
    v_mfma_f32_32x32x16_bf16 v[100:115], v[40:43], v[48:51], v[100:115]
    ds_read_b128 v[40:43], v7 offset:4096
    ds_read_b128 v[48:51], v11 offset:20480
    s_waitcnt lgkmcnt(6)
    v_mfma_f32_32x32x16_bf16 v[52:67], v[20:23], v[28:31], v[52:67]
    s_waitcnt lgkmcnt(5)
    v_mfma_f32_32x32x16_bf16 v[68:83], v[24:27], v[28:31], v[68:83]
    s_waitcnt lgkmcnt(0)
    s_barrier
    ds_read_b128 v[28:31], v16 offset:0
    v_mfma_f32_32x32x16_bf16 v[84:99], v[20:23], v[32:35], v[84:99]
    ds_read_b128 v[20:23], v4 offset:32768
    v_mfma_f32_32x32x16_bf16 v[100:115], v[24:27], v[32:35], v[100:115]
    ds_read_b128 v[24:27], v4 offset:36864
    ds_read_b128 v[32:35], v16 offset:4096
    v_mfma_f32_32x32x16_bf16 v[52:67], v[36:39], v[44:47], v[52:67]
    v_mfma_f32_32x32x16_bf16 v[68:83], v[40:43], v[44:47], v[68:83]
    ds_read_b128 v[44:47], v17 offset:0
    v_mfma_f32_32x32x16_bf16 v[84:99], v[36:39], v[48:51], v[84:99]
    ds_read_b128 v[36:39], v5 offset:32768
    v_mfma_f32_32x32x16_bf16 v[100:115], v[40:43], v[48:51], v[100:115]
    ds_read_b128 v[40:43], v5 offset:36864
    ds_read_b128 v[48:51], v17 offset:4096
    s_waitcnt lgkmcnt(6)
    v_mfma_f32_32x32x16_bf16 v[52:67], v[20:23], v[28:31], v[52:67]
    s_waitcnt lgkmcnt(5)
    v_mfma_f32_32x32x16_bf16 v[68:83], v[24:27], v[28:31], v[68:83]
    ds_read_b128 v[28:31], v18 offset:0
    s_waitcnt lgkmcnt(5)
    v_mfma_f32_32x32x16_bf16 v[84:99], v[20:23], v[32:35], v[84:99]
    ds_read_b128 v[20:23], v6 offset:32768
    v_mfma_f32_32x32x16_bf16 v[100:115], v[24:27], v[32:35], v[100:115]
    ds_read_b128 v[24:27], v6 offset:36864
    ds_read_b128 v[32:35], v18 offset:4096
    s_waitcnt lgkmcnt(6)
    v_mfma_f32_32x32x16_bf16 v[52:67], v[36:39], v[44:47], v[52:67]
    s_waitcnt lgkmcnt(5)
    v_mfma_f32_32x32x16_bf16 v[68:83], v[40:43], v[44:47], v[68:83]
    ds_read_b128 v[44:47], v19 offset:0
    s_waitcnt lgkmcnt(5)
    v_mfma_f32_32x32x16_bf16 v[84:99], v[36:39], v[48:51], v[84:99]
    ds_read_b128 v[36:39], v7 offset:32768
    v_mfma_f32_32x32x16_bf16 v[100:115], v[40:43], v[48:51], v[100:115]
    ds_read_b128 v[40:43], v7 offset:36864
    ds_read_b128 v[48:51], v19 offset:4096
    s_waitcnt lgkmcnt(6)
    v_mfma_f32_32x32x16_bf16 v[52:67], v[20:23], v[28:31], v[52:67]
    s_waitcnt lgkmcnt(5)
    v_mfma_f32_32x32x16_bf16 v[68:83], v[24:27], v[28:31], v[68:83]
    s_waitcnt lgkmcnt(0)
    s_barrier
    ds_read_b128 v[28:31], v8 offset:0
    v_mfma_f32_32x32x16_bf16 v[84:99], v[20:23], v[32:35], v[84:99]
    ds_read_b128 v[20:23], v12 offset:16384
    v_mfma_f32_32x32x16_bf16 v[100:115], v[24:27], v[32:35], v[100:115]
    ds_read_b128 v[24:27], v12 offset:20480
    ds_read_b128 v[32:35], v8 offset:4096
    v_mfma_f32_32x32x16_bf16 v[52:67], v[36:39], v[44:47], v[52:67]
    v_mfma_f32_32x32x16_bf16 v[68:83], v[40:43], v[44:47], v[68:83]
    ds_read_b128 v[44:47], v9 offset:0
    v_mfma_f32_32x32x16_bf16 v[84:99], v[36:39], v[48:51], v[84:99]
    ds_read_b128 v[36:39], v13 offset:16384
    v_mfma_f32_32x32x16_bf16 v[100:115], v[40:43], v[48:51], v[100:115]
    ds_read_b128 v[40:43], v13 offset:20480
    ds_read_b128 v[48:51], v9 offset:4096
    s_waitcnt lgkmcnt(6)
    v_mfma_f32_32x32x16_bf16 v[52:67], v[20:23], v[28:31], v[52:67]
    s_waitcnt lgkmcnt(5)
    v_mfma_f32_32x32x16_bf16 v[68:83], v[24:27], v[28:31], v[68:83]
    ds_read_b128 v[28:31], v10 offset:0
    s_waitcnt lgkmcnt(5)
    v_mfma_f32_32x32x16_bf16 v[84:99], v[20:23], v[32:35], v[84:99]
    ds_read_b128 v[20:23], v14 offset:16384
    v_mfma_f32_32x32x16_bf16 v[100:115], v[24:27], v[32:35], v[100:115]
    ds_read_b128 v[24:27], v14 offset:20480
    ds_read_b128 v[32:35], v10 offset:4096
    s_waitcnt lgkmcnt(6)
    v_mfma_f32_32x32x16_bf16 v[52:67], v[36:39], v[44:47], v[52:67]
    s_waitcnt lgkmcnt(5)
    v_mfma_f32_32x32x16_bf16 v[68:83], v[40:43], v[44:47], v[68:83]
    ds_read_b128 v[44:47], v11 offset:0
    s_waitcnt lgkmcnt(5)
    v_mfma_f32_32x32x16_bf16 v[84:99], v[36:39], v[48:51], v[84:99]
    ds_read_b128 v[36:39], v15 offset:16384
    v_mfma_f32_32x32x16_bf16 v[100:115], v[40:43], v[48:51], v[100:115]
    ds_read_b128 v[40:43], v15 offset:20480
    ds_read_b128 v[48:51], v11 offset:4096
    s_waitcnt lgkmcnt(6)
    v_mfma_f32_32x32x16_bf16 v[52:67], v[20:23], v[28:31], v[52:67]
    s_waitcnt lgkmcnt(5)
    v_mfma_f32_32x32x16_bf16 v[68:83], v[24:27], v[28:31], v[68:83]
    s_waitcnt lgkmcnt(0)
    s_barrier
    ds_read_b128 v[28:31], v8 offset:32768
    v_mfma_f32_32x32x16_bf16 v[84:99], v[20:23], v[32:35], v[84:99]
    ds_read_b128 v[20:23], v4 offset:16384
    v_mfma_f32_32x32x16_bf16 v[100:115], v[24:27], v[32:35], v[100:115]
    ds_read_b128 v[24:27], v4 offset:20480
    ds_read_b128 v[32:35], v8 offset:36864
    v_mfma_f32_32x32x16_bf16 v[52:67], v[36:39], v[44:47], v[52:67]
    v_mfma_f32_32x32x16_bf16 v[68:83], v[40:43], v[44:47], v[68:83]
    ds_read_b128 v[44:47], v9 offset:32768
    v_mfma_f32_32x32x16_bf16 v[84:99], v[36:39], v[48:51], v[84:99]
    ds_read_b128 v[36:39], v5 offset:16384
    v_mfma_f32_32x32x16_bf16 v[100:115], v[40:43], v[48:51], v[100:115]
    ds_read_b128 v[40:43], v5 offset:20480
    ds_read_b128 v[48:51], v9 offset:36864
    s_waitcnt lgkmcnt(6)
    v_mfma_f32_32x32x16_bf16 v[52:67], v[20:23], v[28:31], v[52:67]
    s_waitcnt lgkmcnt(5)
    v_mfma_f32_32x32x16_bf16 v[68:83], v[24:27], v[28:31], v[68:83]
    ds_read_b128 v[28:31], v10 offset:32768
    s_waitcnt lgkmcnt(5)
    v_mfma_f32_32x32x16_bf16 v[84:99], v[20:23], v[32:35], v[84:99]
    ds_read_b128 v[20:23], v6 offset:16384
    v_mfma_f32_32x32x16_bf16 v[100:115], v[24:27], v[32:35], v[100:115]
    ds_read_b128 v[24:27], v6 offset:20480
    ds_read_b128 v[32:35], v10 offset:36864
    s_waitcnt lgkmcnt(6)
    v_mfma_f32_32x32x16_bf16 v[52:67], v[36:39], v[44:47], v[52:67]
    s_waitcnt lgkmcnt(5)
    v_mfma_f32_32x32x16_bf16 v[68:83], v[40:43], v[44:47], v[68:83]
    ds_read_b128 v[44:47], v11 offset:32768
    s_waitcnt lgkmcnt(5)
    v_mfma_f32_32x32x16_bf16 v[84:99], v[36:39], v[48:51], v[84:99]
    ds_read_b128 v[36:39], v7 offset:16384
    v_mfma_f32_32x32x16_bf16 v[100:115], v[40:43], v[48:51], v[100:115]
    ds_read_b128 v[40:43], v7 offset:20480
    ds_read_b128 v[48:51], v11 offset:36864
    s_waitcnt lgkmcnt(6)
    v_mfma_f32_32x32x16_bf16 v[52:67], v[20:23], v[28:31], v[52:67]
    s_waitcnt lgkmcnt(5)
    v_mfma_f32_32x32x16_bf16 v[68:83], v[24:27], v[28:31], v[68:83]
    s_waitcnt lgkmcnt(0)
    s_barrier
    ds_read_b128 v[28:31], v16 offset:16384
    v_mfma_f32_32x32x16_bf16 v[84:99], v[20:23], v[32:35], v[84:99]
    ds_read_b128 v[20:23], v12 offset:0
    v_mfma_f32_32x32x16_bf16 v[100:115], v[24:27], v[32:35], v[100:115]
    ds_read_b128 v[24:27], v12 offset:4096
    ds_read_b128 v[32:35], v16 offset:20480
    v_mfma_f32_32x32x16_bf16 v[52:67], v[36:39], v[44:47], v[52:67]
    v_mfma_f32_32x32x16_bf16 v[68:83], v[40:43], v[44:47], v[68:83]
    ds_read_b128 v[44:47], v17 offset:16384
    v_mfma_f32_32x32x16_bf16 v[84:99], v[36:39], v[48:51], v[84:99]
    ds_read_b128 v[36:39], v13 offset:0
    v_mfma_f32_32x32x16_bf16 v[100:115], v[40:43], v[48:51], v[100:115]
    ds_read_b128 v[40:43], v13 offset:4096
    ds_read_b128 v[48:51], v17 offset:20480
    s_waitcnt lgkmcnt(6)
    v_mfma_f32_32x32x16_bf16 v[52:67], v[20:23], v[28:31], v[52:67]
    s_waitcnt lgkmcnt(5)
    v_mfma_f32_32x32x16_bf16 v[68:83], v[24:27], v[28:31], v[68:83]
    ds_read_b128 v[28:31], v18 offset:16384
    s_waitcnt lgkmcnt(5)
    v_mfma_f32_32x32x16_bf16 v[84:99], v[20:23], v[32:35], v[84:99]
    ds_read_b128 v[20:23], v14 offset:0
    v_mfma_f32_32x32x16_bf16 v[100:115], v[24:27], v[32:35], v[100:115]
    ds_read_b128 v[24:27], v14 offset:4096
    ds_read_b128 v[32:35], v18 offset:20480
    s_waitcnt lgkmcnt(6)
    v_mfma_f32_32x32x16_bf16 v[52:67], v[36:39], v[44:47], v[52:67]
    s_waitcnt lgkmcnt(5)
    v_mfma_f32_32x32x16_bf16 v[68:83], v[40:43], v[44:47], v[68:83]
    ds_read_b128 v[44:47], v19 offset:16384
    s_waitcnt lgkmcnt(5)
    v_mfma_f32_32x32x16_bf16 v[84:99], v[36:39], v[48:51], v[84:99]
    ds_read_b128 v[36:39], v15 offset:0
    v_mfma_f32_32x32x16_bf16 v[100:115], v[40:43], v[48:51], v[100:115]
    ds_read_b128 v[40:43], v15 offset:4096
    ds_read_b128 v[48:51], v19 offset:20480
    s_waitcnt lgkmcnt(6)
    v_mfma_f32_32x32x16_bf16 v[52:67], v[20:23], v[28:31], v[52:67]
    s_waitcnt lgkmcnt(5)
    v_mfma_f32_32x32x16_bf16 v[68:83], v[24:27], v[28:31], v[68:83]
    s_waitcnt lgkmcnt(0)
    s_barrier
    ds_read_b128 v[28:31], v8 offset:16384
    v_mfma_f32_32x32x16_bf16 v[84:99], v[20:23], v[32:35], v[84:99]
    ds_read_b128 v[20:23], v4 offset:0
    v_mfma_f32_32x32x16_bf16 v[100:115], v[24:27], v[32:35], v[100:115]
    ds_read_b128 v[24:27], v4 offset:4096
    ds_read_b128 v[32:35], v8 offset:20480
    v_mfma_f32_32x32x16_bf16 v[52:67], v[36:39], v[44:47], v[52:67]
    v_mfma_f32_32x32x16_bf16 v[68:83], v[40:43], v[44:47], v[68:83]
    ds_read_b128 v[44:47], v9 offset:16384
    v_mfma_f32_32x32x16_bf16 v[84:99], v[36:39], v[48:51], v[84:99]
    ds_read_b128 v[36:39], v5 offset:0
    v_mfma_f32_32x32x16_bf16 v[100:115], v[40:43], v[48:51], v[100:115]
    ds_read_b128 v[40:43], v5 offset:4096
    ds_read_b128 v[48:51], v9 offset:20480
    s_add_u32 s32, s32, 1
    s_cmp_lt_u32 s32, 2
    s_cbranch_scc1 b_loop
    s_waitcnt lgkmcnt(0)
    s_setprio 3
    s_nop 7
    v_fma_f32 v8, v116, v52, v53
    v_fma_f32 v9, v116, v84, v85
    v_fma_f32 v8, -v117, v84, v8
    v_fma_f32 v9, v117, v52, v9
    v_fma_f32 v4, v116, v8, v54
    v_fma_f32 v5, v116, v9, v86
    v_fma_f32 v4, -v117, v9, v4
    v_fma_f32 v5, v117, v8, v5
    v_fma_f32 v8, v116, v4, v55
    v_fma_f32 v9, v116, v5, v87
    v_fma_f32 v8, -v117, v5, v8
    v_fma_f32 v9, v117, v4, v9
    v_fma_f32 v4, v116, v8, v56
    v_fma_f32 v5, v116, v9, v88
    v_fma_f32 v4, -v117, v9, v4
    v_fma_f32 v5, v117, v8, v5
    v_fma_f32 v8, v116, v4, v57
    v_fma_f32 v9, v116, v5, v89
    v_fma_f32 v8, -v117, v5, v8
    v_fma_f32 v9, v117, v4, v9
    v_fma_f32 v4, v116, v8, v58
    v_fma_f32 v5, v116, v9, v90
    v_fma_f32 v4, -v117, v9, v4
    v_fma_f32 v5, v117, v8, v5
    v_fma_f32 v8, v116, v4, v59
    v_fma_f32 v9, v116, v5, v91
    v_fma_f32 v8, -v117, v5, v8
    v_fma_f32 v9, v117, v4, v9
    v_fma_f32 v4, v116, v8, v60
    v_fma_f32 v5, v116, v9, v92
    v_fma_f32 v4, -v117, v9, v4
    v_fma_f32 v5, v117, v8, v5
    v_fma_f32 v8, v116, v4, v61
    v_fma_f32 v9, v116, v5, v93
    v_fma_f32 v8, -v117, v5, v8
    v_fma_f32 v9, v117, v4, v9
    v_fma_f32 v4, v116, v8, v62
    v_fma_f32 v5, v116, v9, v94
    v_fma_f32 v4, -v117, v9, v4
    v_fma_f32 v5, v117, v8, v5
    v_fma_f32 v8, v116, v4, v63
    v_fma_f32 v9, v116, v5, v95
    v_fma_f32 v8, -v117, v5, v8
    v_fma_f32 v9, v117, v4, v9
    v_fma_f32 v4, v116, v8, v64
    v_fma_f32 v5, v116, v9, v96
    v_fma_f32 v4, -v117, v9, v4
    v_fma_f32 v5, v117, v8, v5
    v_fma_f32 v8, v116, v4, v65
    v_fma_f32 v9, v116, v5, v97
    v_fma_f32 v8, -v117, v5, v8
    v_fma_f32 v9, v117, v4, v9
    v_fma_f32 v4, v116, v8, v66
    v_fma_f32 v5, v116, v9, v98
    v_fma_f32 v4, -v117, v9, v4
    v_fma_f32 v5, v117, v8, v5
    v_fma_f32 v8, v116, v4, v67
    v_fma_f32 v9, v116, v5, v99
    v_fma_f32 v8, -v117, v5, v8
    v_fma_f32 v9, v117, v4, v9
    v_fma_f32 v4, v116, v8, v68
    v_fma_f32 v5, v116, v9, v100
    v_fma_f32 v4, -v117, v9, v4
    v_fma_f32 v5, v117, v8, v5
    v_fma_f32 v8, v116, v4, v69
    v_fma_f32 v9, v116, v5, v101
    v_fma_f32 v8, -v117, v5, v8
    v_fma_f32 v9, v117, v4, v9
    v_fma_f32 v4, v116, v8, v70
    v_fma_f32 v5, v116, v9, v102
    v_fma_f32 v4, -v117, v9, v4
    v_fma_f32 v5, v117, v8, v5
    v_fma_f32 v8, v116, v4, v71
    v_fma_f32 v9, v116, v5, v103
    v_fma_f32 v8, -v117, v5, v8
    v_fma_f32 v9, v117, v4, v9
    v_fma_f32 v4, v116, v8, v72
    v_fma_f32 v5, v116, v9, v104
    v_fma_f32 v4, -v117, v9, v4
    v_fma_f32 v5, v117, v8, v5
    v_fma_f32 v8, v116, v4, v73
    v_fma_f32 v9, v116, v5, v105
    v_fma_f32 v8, -v117, v5, v8
    v_fma_f32 v9, v117, v4, v9
    v_fma_f32 v4, v116, v8, v74
    v_fma_f32 v5, v116, v9, v106
    v_fma_f32 v4, -v117, v9, v4
    v_fma_f32 v5, v117, v8, v5
    v_fma_f32 v8, v116, v4, v75
    v_fma_f32 v9, v116, v5, v107
    v_fma_f32 v8, -v117, v5, v8
    v_fma_f32 v9, v117, v4, v9
    v_fma_f32 v4, v116, v8, v76
    v_fma_f32 v5, v116, v9, v108
    v_fma_f32 v4, -v117, v9, v4
    v_fma_f32 v5, v117, v8, v5
    v_fma_f32 v8, v116, v4, v77
    v_fma_f32 v9, v116, v5, v109
    v_fma_f32 v8, -v117, v5, v8
    v_fma_f32 v9, v117, v4, v9
    v_fma_f32 v4, v116, v8, v78
    v_fma_f32 v5, v116, v9, v110
    v_fma_f32 v4, -v117, v9, v4
    v_fma_f32 v5, v117, v8, v5
    v_fma_f32 v8, v116, v4, v79
    v_fma_f32 v9, v116, v5, v111
    v_fma_f32 v8, -v117, v5, v8
    v_fma_f32 v9, v117, v4, v9
    v_fma_f32 v4, v116, v8, v80
    v_fma_f32 v5, v116, v9, v112
    v_fma_f32 v4, -v117, v9, v4
    v_fma_f32 v5, v117, v8, v5
    v_fma_f32 v8, v116, v4, v81
    v_fma_f32 v9, v116, v5, v113
    v_fma_f32 v8, -v117, v5, v8
    v_fma_f32 v9, v117, v4, v9
    v_fma_f32 v4, v116, v8, v82
    v_fma_f32 v5, v116, v9, v114
    v_fma_f32 v4, -v117, v9, v4
    v_fma_f32 v5, v117, v8, v5
    v_fma_f32 v8, v116, v4, v83
    v_fma_f32 v9, v116, v5, v115
    v_fma_f32 v8, -v117, v5, v8
    v_fma_f32 v9, v117, v4, v9
    v_mov_b32 v6, v8
    v_mov_b32 v7, v9
    v_mov_b32 v10, v8
    v_mov_b32 v11, v9
    s_nop 0
    v_permlane32_swap_b32 v6, v10
    v_permlane32_swap_b32 v7, v11
    v_fma_f32 v16, v120, v6, v10
    v_fma_f32 v17, v120, v7, v11
    v_fma_f32 v16, -v121, v7, v16
    v_fma_f32 v14, v121, v6, v17
    v_mov_b32 v12, v16
    v_mov_b32 v13, s80
    v_mov_b32 v15, s80
    s_lshl_b32 s34, s12, 1
    s_add_u32 s34, s34, s28
    s_mul_i32 s35, s34, 10240
    s_add_u32 s36, s35, 11010048
    s_add_u32 s35, s35, 10682368
    v_lshlrev_b32 v16, 4, v124
    s_mov_b32 exec_hi, 0
    buffer_store_dwordx4 v[12:15], v16, s[8:11], s36 offen sc1
    s_mov_b64 exec, -1
    v_mul_u32_u24 v17, 163840, v125
    v_add_u32 v17, v17, v16
    v_mov_b32 v20, 0
    v_mov_b32 v21, s80
    v_mov_b32 v22, 0
    v_mov_b32 v23, s80
    v_mov_b32 v24, 0
    v_mov_b32 v25, s80
    v_mov_b32 v26, 0
    v_mov_b32 v27, s80
    v_mov_b32 v28, 0
    v_mov_b32 v29, s80
    v_mov_b32 v30, 0
    v_mov_b32 v31, s80
    v_mov_b32 v32, 0
    v_mov_b32 v33, s80
    v_mov_b32 v34, 0
    v_mov_b32 v35, s80
    v_mov_b32 v36, 0
    v_mov_b32 v37, s80
    v_mov_b32 v38, 0
    v_mov_b32 v39, s80
    v_mov_b32 v40, 0
    v_mov_b32 v41, s80
    v_mov_b32 v42, 0
    v_mov_b32 v43, s80
    v_mov_b32 v44, 0
    v_mov_b32 v45, s80
    v_mov_b32 v46, 0
    v_mov_b32 v47, s80
    v_mov_b32 v48, 0
    v_mov_b32 v49, s80
    v_mov_b32 v50, 0
    v_mov_b32 v51, s80
    v_mul_f32 v18, v119, v52
    v_mul_f32 v52, v118, v52
    v_fma_f32 v52, -v119, v84, v52
    v_fma_f32 v84, v118, v84, v18
    v_mul_f32 v19, v119, v53
    v_mul_f32 v53, v118, v53
    v_fma_f32 v53, -v119, v85, v53
    v_fma_f32 v85, v118, v85, v19
    v_mul_f32 v18, v119, v54
    v_mul_f32 v54, v118, v54
    v_fma_f32 v54, -v119, v86, v54
    v_fma_f32 v86, v118, v86, v18
    v_mul_f32 v19, v119, v55
    v_mul_f32 v55, v118, v55
    v_fma_f32 v55, -v119, v87, v55
    v_fma_f32 v87, v118, v87, v19
    v_mul_f32 v18, v119, v56
    v_mul_f32 v56, v118, v56
    v_fma_f32 v56, -v119, v88, v56
    v_fma_f32 v88, v118, v88, v18
    v_mul_f32 v19, v119, v57
    v_mul_f32 v57, v118, v57
    v_fma_f32 v57, -v119, v89, v57
    v_fma_f32 v89, v118, v89, v19
    v_mul_f32 v18, v119, v58
    v_mul_f32 v58, v118, v58
    v_fma_f32 v58, -v119, v90, v58
    v_fma_f32 v90, v118, v90, v18
    v_mul_f32 v19, v119, v59
    v_mul_f32 v59, v118, v59
    v_fma_f32 v59, -v119, v91, v59
    v_fma_f32 v91, v118, v91, v19
    v_mul_f32 v18, v119, v60
    v_mul_f32 v60, v118, v60
    v_fma_f32 v60, -v119, v92, v60
    v_fma_f32 v92, v118, v92, v18
    s_cmp_lt_u32 s34, 16
    s_cbranch_scc1 g_3
    s_cmp_ge_u32 s34, 32
    s_cselect_b32 exec_lo, -1, 0
    s_add_u32 s36, s35, 0
    buffer_load_dwordx4 v[20:23], v17, s[8:11], s36 offen sc1
g_3:
    s_cmp_lt_u32 s34, 15
    s_cbranch_scc1 g_4
    s_cmp_ge_u32 s34, 31
    s_cselect_b32 exec_lo, -1, 0
    s_add_u32 s36, s35, 10240
    buffer_load_dwordx4 v[24:27], v17, s[8:11], s36 offen sc1
g_4:
    s_cmp_lt_u32 s34, 14
    s_cbranch_scc1 g_5
    s_cmp_ge_u32 s34, 30
    s_cselect_b32 exec_lo, -1, 0
    s_add_u32 s36, s35, 20480
    buffer_load_dwordx4 v[28:31], v17, s[8:11], s36 offen sc1
g_5:
    s_cmp_lt_u32 s34, 13
    s_cbranch_scc1 g_6
    s_cmp_ge_u32 s34, 29
    s_cselect_b32 exec_lo, -1, 0
    s_add_u32 s36, s35, 30720
    buffer_load_dwordx4 v[32:35], v17, s[8:11], s36 offen sc1
g_6:
    s_cmp_lt_u32 s34, 12
    s_cbranch_scc1 g_7
    s_cmp_ge_u32 s34, 28
    s_cselect_b32 exec_lo, -1, 0
    s_add_u32 s36, s35, 40960
    buffer_load_dwordx4 v[36:39], v17, s[8:11], s36 offen sc1
g_7:
    s_cmp_lt_u32 s34, 11
    s_cbranch_scc1 g_8
    s_cmp_ge_u32 s34, 27
    s_cselect_b32 exec_lo, -1, 0
    s_add_u32 s36, s35, 51200
    buffer_load_dwordx4 v[40:43], v17, s[8:11], s36 offen sc1
g_8:
    s_cmp_lt_u32 s34, 10
    s_cbranch_scc1 g_9
    s_cmp_ge_u32 s34, 26
    s_cselect_b32 exec_lo, -1, 0
    s_add_u32 s36, s35, 61440
    buffer_load_dwordx4 v[44:47], v17, s[8:11], s36 offen sc1
g_9:
    s_cmp_lt_u32 s34, 9
    s_cbranch_scc1 g_10
    s_cmp_ge_u32 s34, 25
    s_cselect_b32 exec_lo, -1, 0
    s_add_u32 s36, s35, 71680
    buffer_load_dwordx4 v[48:51], v17, s[8:11], s36 offen sc1
g_10:
    s_mov_b64 exec, -1
    v_mul_f32 v19, v119, v61
    v_mul_f32 v61, v118, v61
    v_fma_f32 v61, -v119, v93, v61
    v_fma_f32 v93, v118, v93, v19
    v_mul_f32 v18, v119, v62
    v_mul_f32 v62, v118, v62
    v_fma_f32 v62, -v119, v94, v62
    v_fma_f32 v94, v118, v94, v18
    v_mul_f32 v19, v119, v63
    v_mul_f32 v63, v118, v63
    v_fma_f32 v63, -v119, v95, v63
    v_fma_f32 v95, v118, v95, v19
    v_mul_f32 v18, v119, v64
    v_mul_f32 v64, v118, v64
    v_fma_f32 v64, -v119, v96, v64
    v_fma_f32 v96, v118, v96, v18
    v_mul_f32 v19, v119, v65
    v_mul_f32 v65, v118, v65
    v_fma_f32 v65, -v119, v97, v65
    v_fma_f32 v97, v118, v97, v19
    v_mul_f32 v18, v119, v66
    v_mul_f32 v66, v118, v66
    v_fma_f32 v66, -v119, v98, v66
    v_fma_f32 v98, v118, v98, v18
    v_mul_f32 v19, v119, v67
    v_mul_f32 v67, v118, v67
    v_fma_f32 v67, -v119, v99, v67
    v_fma_f32 v99, v118, v99, v19
    v_mul_f32 v18, v119, v68
    v_mul_f32 v68, v118, v68
    v_fma_f32 v68, -v119, v100, v68
    v_fma_f32 v100, v118, v100, v18
    v_mul_f32 v19, v119, v69
    v_mul_f32 v69, v118, v69
    v_fma_f32 v69, -v119, v101, v69
    v_fma_f32 v101, v118, v101, v19
    v_mul_f32 v18, v119, v70
    v_mul_f32 v70, v118, v70
    v_fma_f32 v70, -v119, v102, v70
    v_fma_f32 v102, v118, v102, v18
    v_mul_f32 v19, v119, v71
    v_mul_f32 v71, v118, v71
    v_fma_f32 v71, -v119, v103, v71
    v_fma_f32 v103, v118, v103, v19
    v_mul_f32 v18, v119, v72
    v_mul_f32 v72, v118, v72
    v_fma_f32 v72, -v119, v104, v72
    v_fma_f32 v104, v118, v104, v18
    v_mul_f32 v19, v119, v73
    v_mul_f32 v73, v118, v73
    v_fma_f32 v73, -v119, v105, v73
    v_fma_f32 v105, v118, v105, v19
    v_mul_f32 v18, v119, v74
    v_mul_f32 v74, v118, v74
    v_fma_f32 v74, -v119, v106, v74
    v_fma_f32 v106, v118, v106, v18
    v_mul_f32 v19, v119, v75
    v_mul_f32 v75, v118, v75
    v_fma_f32 v75, -v119, v107, v75
    v_fma_f32 v107, v118, v107, v19
    v_mul_f32 v18, v119, v76
    v_mul_f32 v76, v118, v76
    v_fma_f32 v76, -v119, v108, v76
    v_fma_f32 v108, v118, v108, v18
    v_mul_f32 v19, v119, v77
    v_mul_f32 v77, v118, v77
    v_fma_f32 v77, -v119, v109, v77
    v_fma_f32 v109, v118, v109, v19
    v_mul_f32 v18, v119, v78
    v_mul_f32 v78, v118, v78
    v_fma_f32 v78, -v119, v110, v78
    v_fma_f32 v110, v118, v110, v18
    v_mul_f32 v19, v119, v79
    v_mul_f32 v79, v118, v79
    v_fma_f32 v79, -v119, v111, v79
    v_fma_f32 v111, v118, v111, v19
    v_mul_f32 v18, v119, v80
    v_mul_f32 v80, v118, v80
    v_fma_f32 v80, -v119, v112, v80
    v_fma_f32 v112, v118, v112, v18
    v_mul_f32 v19, v119, v81
    v_mul_f32 v81, v118, v81
    v_fma_f32 v81, -v119, v113, v81
    v_fma_f32 v113, v118, v113, v19
    v_mul_f32 v18, v119, v82
    v_mul_f32 v82, v118, v82
    v_fma_f32 v82, -v119, v114, v82
    v_fma_f32 v114, v118, v114, v18
    v_mul_f32 v19, v119, v83
    v_mul_f32 v83, v118, v83
    v_fma_f32 v83, -v119, v115, v83
    v_fma_f32 v115, v118, v115, v19
    v_mul_f32 v14, v122, v122
    v_mul_f32 v15, v122, v123
    v_fma_f32 v14, -v123, v123, v14
    v_fma_f32 v9, v123, v122, v15
    v_mov_b32 v8, v14
    v_mul_f32 v14, v8, v8
    v_mul_f32 v15, v8, v9
    v_fma_f32 v14, -v9, v9, v14
    v_fma_f32 v9, v9, v8, v15
    v_mov_b32 v8, v14
    v_mul_f32 v14, v8, v8
    v_mul_f32 v15, v8, v9
    v_fma_f32 v14, -v9, v9, v14
    v_fma_f32 v9, v9, v8, v15
    v_mov_b32 v8, v14
    v_mul_f32 v14, v8, v8
    v_mul_f32 v15, v8, v9
    v_fma_f32 v14, -v9, v9, v14
    v_fma_f32 v9, v9, v8, v15
    v_mov_b32 v8, v14
    s_mov_b32 s37, 0
b_poll0:
    s_waitcnt vmcnt(0)
    v_xor_b32 v12, s80, v21
    v_xor_b32 v13, s80, v23
    v_or_b32 v14, v12, v13
    v_xor_b32 v12, s80, v25
    v_xor_b32 v13, s80, v27
    v_or3_b32 v14, v14, v12, v13
    v_xor_b32 v12, s80, v29
    v_xor_b32 v13, s80, v31
    v_or3_b32 v14, v14, v12, v13
    v_xor_b32 v12, s80, v33
    v_xor_b32 v13, s80, v35
    v_or3_b32 v14, v14, v12, v13
    v_xor_b32 v12, s80, v37
    v_xor_b32 v13, s80, v39
    v_or3_b32 v14, v14, v12, v13
    v_xor_b32 v12, s80, v41
    v_xor_b32 v13, s80, v43
    v_or3_b32 v14, v14, v12, v13
    v_xor_b32 v12, s80, v45
    v_xor_b32 v13, s80, v47
    v_or3_b32 v14, v14, v12, v13
    v_xor_b32 v12, s80, v49
    v_xor_b32 v13, s80, v51
    v_or3_b32 v14, v14, v12, v13
    v_cmp_ne_u32 vcc, 0, v14
    s_nop 0
    s_cmp_eq_u64 vcc, 0
    s_cbranch_scc1 b_poll0_ok
    s_add_u32 s37, s37, 1
    s_cmp_gt_u32 s37, 200000
    s_cbranch_scc1 b_poll0_ok
    s_sleep 6
    s_cmp_lt_u32 s34, 16
    s_cbranch_scc1 g_11
    s_cmp_ge_u32 s34, 32
    s_cselect_b32 exec_lo, -1, 0
    s_add_u32 s36, s35, 0
    buffer_load_dwordx4 v[20:23], v17, s[8:11], s36 offen sc1
g_11:
    s_cmp_lt_u32 s34, 15
    s_cbranch_scc1 g_12
    s_cmp_ge_u32 s34, 31
    s_cselect_b32 exec_lo, -1, 0
    s_add_u32 s36, s35, 10240
    buffer_load_dwordx4 v[24:27], v17, s[8:11], s36 offen sc1
g_12:
    s_cmp_lt_u32 s34, 14
    s_cbranch_scc1 g_13
    s_cmp_ge_u32 s34, 30
    s_cselect_b32 exec_lo, -1, 0
    s_add_u32 s36, s35, 20480
    buffer_load_dwordx4 v[28:31], v17, s[8:11], s36 offen sc1
g_13:
    s_cmp_lt_u32 s34, 13
    s_cbranch_scc1 g_14
    s_cmp_ge_u32 s34, 29
    s_cselect_b32 exec_lo, -1, 0
    s_add_u32 s36, s35, 30720
    buffer_load_dwordx4 v[32:35], v17, s[8:11], s36 offen sc1
g_14:
    s_cmp_lt_u32 s34, 12
    s_cbranch_scc1 g_15
    s_cmp_ge_u32 s34, 28
    s_cselect_b32 exec_lo, -1, 0
    s_add_u32 s36, s35, 40960
    buffer_load_dwordx4 v[36:39], v17, s[8:11], s36 offen sc1
g_15:
    s_cmp_lt_u32 s34, 11
    s_cbranch_scc1 g_16
    s_cmp_ge_u32 s34, 27
    s_cselect_b32 exec_lo, -1, 0
    s_add_u32 s36, s35, 51200
    buffer_load_dwordx4 v[40:43], v17, s[8:11], s36 offen sc1
g_16:
    s_cmp_lt_u32 s34, 10
    s_cbranch_scc1 g_17
    s_cmp_ge_u32 s34, 26
    s_cselect_b32 exec_lo, -1, 0
    s_add_u32 s36, s35, 61440
    buffer_load_dwordx4 v[44:47], v17, s[8:11], s36 offen sc1
g_17:
    s_cmp_lt_u32 s34, 9
    s_cbranch_scc1 g_18
    s_cmp_ge_u32 s34, 25
    s_cselect_b32 exec_lo, -1, 0
    s_add_u32 s36, s35, 71680
    buffer_load_dwordx4 v[48:51], v17, s[8:11], s36 offen sc1
g_18:
    s_mov_b64 exec, -1
    s_branch b_poll0
b_poll0_ok:
    v_mov_b32 v4, v20
    v_mov_b32 v5, v22
    v_fma_f32 v10, v122, v4, v24
    v_fma_f32 v11, v122, v5, v26
    v_fma_f32 v10, -v123, v5, v10
    v_fma_f32 v11, v123, v4, v11
    v_fma_f32 v4, v122, v10, v28
    v_fma_f32 v5, v122, v11, v30
    v_fma_f32 v4, -v123, v11, v4
    v_fma_f32 v5, v123, v10, v5
    v_fma_f32 v10, v122, v4, v32
    v_fma_f32 v11, v122, v5, v34
    v_fma_f32 v10, -v123, v5, v10
    v_fma_f32 v11, v123, v4, v11
    v_fma_f32 v4, v122, v10, v36
    v_fma_f32 v5, v122, v11, v38
    v_fma_f32 v4, -v123, v11, v4
    v_fma_f32 v5, v123, v10, v5
    v_fma_f32 v10, v122, v4, v40
    v_fma_f32 v11, v122, v5, v42
    v_fma_f32 v10, -v123, v5, v10
    v_fma_f32 v11, v123, v4, v11
    v_fma_f32 v4, v122, v10, v44
    v_fma_f32 v5, v122, v11, v46
    v_fma_f32 v4, -v123, v11, v4
    v_fma_f32 v5, v123, v10, v5
    v_fma_f32 v10, v122, v4, v48
    v_fma_f32 v11, v122, v5, v50
    v_fma_f32 v10, -v123, v5, v10
    v_fma_f32 v11, v123, v4, v11
    s_cmp_lt_u32 s34, 8
    s_cbranch_scc1 g_19
    s_cmp_ge_u32 s34, 24
    s_cselect_b32 exec_lo, -1, 0
    s_add_u32 s36, s35, 81920
    buffer_load_dwordx4 v[20:23], v17, s[8:11], s36 offen sc1
g_19:
    s_cmp_lt_u32 s34, 7
    s_cbranch_scc1 g_20
    s_cmp_ge_u32 s34, 23
    s_cselect_b32 exec_lo, -1, 0
    s_add_u32 s36, s35, 92160
    buffer_load_dwordx4 v[24:27], v17, s[8:11], s36 offen sc1
g_20:
    s_cmp_lt_u32 s34, 6
    s_cbranch_scc1 g_21
    s_cmp_ge_u32 s34, 22
    s_cselect_b32 exec_lo, -1, 0
    s_add_u32 s36, s35, 102400
    buffer_load_dwordx4 v[28:31], v17, s[8:11], s36 offen sc1
g_21:
    s_cmp_lt_u32 s34, 5
    s_cbranch_scc1 g_22
    s_cmp_ge_u32 s34, 21
    s_cselect_b32 exec_lo, -1, 0
    s_add_u32 s36, s35, 112640
    buffer_load_dwordx4 v[32:35], v17, s[8:11], s36 offen sc1
g_22:
    s_cmp_lt_u32 s34, 4
    s_cbranch_scc1 g_23
    s_cmp_ge_u32 s34, 20
    s_cselect_b32 exec_lo, -1, 0
    s_add_u32 s36, s35, 122880
    buffer_load_dwordx4 v[36:39], v17, s[8:11], s36 offen sc1
g_23:
    s_cmp_lt_u32 s34, 3
    s_cbranch_scc1 g_24
    s_cmp_ge_u32 s34, 19
    s_cselect_b32 exec_lo, -1, 0
    s_add_u32 s36, s35, 133120
    buffer_load_dwordx4 v[40:43], v17, s[8:11], s36 offen sc1
g_24:
    s_cmp_lt_u32 s34, 2
    s_cbranch_scc1 g_25
    s_cmp_ge_u32 s34, 18
    s_cselect_b32 exec_lo, -1, 0
    s_add_u32 s36, s35, 143360
    buffer_load_dwordx4 v[44:47], v17, s[8:11], s36 offen sc1
g_25:
    s_cmp_lt_u32 s34, 1
    s_cbranch_scc1 g_26
    s_cmp_ge_u32 s34, 17
    s_cselect_b32 exec_lo, -1, 0
    s_add_u32 s36, s35, 153600
    buffer_load_dwordx4 v[48:51], v17, s[8:11], s36 offen sc1
g_26:
    s_mov_b64 exec, -1
    s_mov_b32 s37, 0
b_poll1:
    s_waitcnt vmcnt(0)
    v_xor_b32 v12, s80, v21
    v_xor_b32 v13, s80, v23
    v_or_b32 v14, v12, v13
    v_xor_b32 v12, s80, v25
    v_xor_b32 v13, s80, v27
    v_or3_b32 v14, v14, v12, v13
    v_xor_b32 v12, s80, v29
    v_xor_b32 v13, s80, v31
    v_or3_b32 v14, v14, v12, v13
    v_xor_b32 v12, s80, v33
    v_xor_b32 v13, s80, v35
    v_or3_b32 v14, v14, v12, v13
    v_xor_b32 v12, s80, v37
    v_xor_b32 v13, s80, v39
    v_or3_b32 v14, v14, v12, v13
    v_xor_b32 v12, s80, v41
    v_xor_b32 v13, s80, v43
    v_or3_b32 v14, v14, v12, v13
    v_xor_b32 v12, s80, v45
    v_xor_b32 v13, s80, v47
    v_or3_b32 v14, v14, v12, v13
    v_xor_b32 v12, s80, v49
    v_xor_b32 v13, s80, v51
    v_or3_b32 v14, v14, v12, v13
    v_cmp_ne_u32 vcc, 0, v14
    s_nop 0
    s_cmp_eq_u64 vcc, 0
    s_cbranch_scc1 b_poll1_ok
    s_add_u32 s37, s37, 1
    s_cmp_gt_u32 s37, 200000
    s_cbranch_scc1 b_poll1_ok
    s_sleep 6
    s_cmp_lt_u32 s34, 8
    s_cbranch_scc1 g_27
    s_cmp_ge_u32 s34, 24
    s_cselect_b32 exec_lo, -1, 0
    s_add_u32 s36, s35, 81920
    buffer_load_dwordx4 v[20:23], v17, s[8:11], s36 offen sc1
g_27:
    s_cmp_lt_u32 s34, 7
    s_cbranch_scc1 g_28
    s_cmp_ge_u32 s34, 23
    s_cselect_b32 exec_lo, -1, 0
    s_add_u32 s36, s35, 92160
    buffer_load_dwordx4 v[24:27], v17, s[8:11], s36 offen sc1
g_28:
    s_cmp_lt_u32 s34, 6
    s_cbranch_scc1 g_29
    s_cmp_ge_u32 s34, 22
    s_cselect_b32 exec_lo, -1, 0
    s_add_u32 s36, s35, 102400
    buffer_load_dwordx4 v[28:31], v17, s[8:11], s36 offen sc1
g_29:
    s_cmp_lt_u32 s34, 5
    s_cbranch_scc1 g_30
    s_cmp_ge_u32 s34, 21
    s_cselect_b32 exec_lo, -1, 0
    s_add_u32 s36, s35, 112640
    buffer_load_dwordx4 v[32:35], v17, s[8:11], s36 offen sc1
g_30:
    s_cmp_lt_u32 s34, 4
    s_cbranch_scc1 g_31
    s_cmp_ge_u32 s34, 20
    s_cselect_b32 exec_lo, -1, 0
    s_add_u32 s36, s35, 122880
    buffer_load_dwordx4 v[36:39], v17, s[8:11], s36 offen sc1
g_31:
    s_cmp_lt_u32 s34, 3
    s_cbranch_scc1 g_32
    s_cmp_ge_u32 s34, 19
    s_cselect_b32 exec_lo, -1, 0
    s_add_u32 s36, s35, 133120
    buffer_load_dwordx4 v[40:43], v17, s[8:11], s36 offen sc1
g_32:
    s_cmp_lt_u32 s34, 2
    s_cbranch_scc1 g_33
    s_cmp_ge_u32 s34, 18
    s_cselect_b32 exec_lo, -1, 0
    s_add_u32 s36, s35, 143360
    buffer_load_dwordx4 v[44:47], v17, s[8:11], s36 offen sc1
g_33:
    s_cmp_lt_u32 s34, 1
    s_cbranch_scc1 g_34
    s_cmp_ge_u32 s34, 17
    s_cselect_b32 exec_lo, -1, 0
    s_add_u32 s36, s35, 153600
    buffer_load_dwordx4 v[48:51], v17, s[8:11], s36 offen sc1
g_34:
    s_mov_b64 exec, -1
    s_branch b_poll1
b_poll1_ok:
    v_fma_f32 v4, v122, v10, v20
    v_fma_f32 v5, v122, v11, v22
    v_fma_f32 v4, -v123, v11, v4
    v_fma_f32 v5, v123, v10, v5
    v_fma_f32 v10, v122, v4, v24
    v_fma_f32 v11, v122, v5, v26
    v_fma_f32 v10, -v123, v5, v10
    v_fma_f32 v11, v123, v4, v11
    v_fma_f32 v4, v122, v10, v28
    v_fma_f32 v5, v122, v11, v30
    v_fma_f32 v4, -v123, v11, v4
    v_fma_f32 v5, v123, v10, v5
    v_fma_f32 v10, v122, v4, v32
    v_fma_f32 v11, v122, v5, v34
    v_fma_f32 v10, -v123, v5, v10
    v_fma_f32 v11, v123, v4, v11
    v_fma_f32 v4, v122, v10, v36
    v_fma_f32 v5, v122, v11, v38
    v_fma_f32 v4, -v123, v11, v4
    v_fma_f32 v5, v123, v10, v5
    v_fma_f32 v10, v122, v4, v40
    v_fma_f32 v11, v122, v5, v42
    v_fma_f32 v10, -v123, v5, v10
    v_fma_f32 v11, v123, v4, v11
    v_fma_f32 v4, v122, v10, v44
    v_fma_f32 v5, v122, v11, v46
    v_fma_f32 v4, -v123, v11, v4
    v_fma_f32 v5, v123, v10, v5
    v_fma_f32 v10, v122, v4, v48
    v_fma_f32 v11, v122, v5, v50
    v_fma_f32 v10, -v123, v5, v10
    v_fma_f32 v11, v123, v4, v11
    v_mov_b32 v16, v10
    v_mov_b32 v17, v11
    v_mov_b32 v18, v10
    v_mov_b32 v19, v11
    s_nop 0
    v_permlane32_swap_b32 v16, v18
    v_permlane32_swap_b32 v17, v19
    v_fma_f32 v14, v8, v16, v18
    v_fma_f32 v15, v8, v17, v19
    v_fma_f32 v14, -v9, v17, v14
    v_fma_f32 v11, v9, v16, v15
    v_mov_b32 v10, v14
    v_fma_f32 v14, v120, v10, v6
    v_fma_f32 v15, v120, v11, v7
    v_fma_f32 v14, -v121, v11, v14
    v_fma_f32 v13, v121, v10, v15
    v_mov_b32 v12, v14
    v_cmp_eq_u32 vcc, 0, v125
    s_nop 1
    v_cndmask_b32 v10, v12, v10, vcc
    v_cndmask_b32 v11, v13, v11, vcc
    v_mul_f32 v14, v10, v118
    v_mul_f32 v15, v10, v119
    v_fma_f32 v14, -v11, v119, v14
    v_fma_f32 v11, v11, v118, v15
    v_mov_b32 v10, v14
    s_lshl_b32 s35, s34, 3
    s_mul_i32 s35, s35, 21504
    s_add_u32 s35, s35, 16777216
    v_mul_u32_u24 v16, 86016, v125
    v_lshl_add_u32 v16, v124, 4, v16
    v_fma_f32 v52, v116, v10, v52
    v_fma_f32 v84, v116, v11, v84
    v_fma_f32 v52, -v117, v11, v52
    v_fma_f32 v84, v117, v10, v84
    v_fma_f32 v53, v116, v52, v53
    v_fma_f32 v85, v116, v84, v85
    v_fma_f32 v53, -v117, v84, v53
    v_fma_f32 v85, v117, v52, v85
    v_fma_f32 v54, v116, v53, v54
    v_fma_f32 v86, v116, v85, v86
    v_fma_f32 v54, -v117, v85, v54
    v_fma_f32 v86, v117, v53, v86
    v_fma_f32 v55, v116, v54, v55
    v_fma_f32 v87, v116, v86, v87
    v_fma_f32 v55, -v117, v86, v55
    v_fma_f32 v87, v117, v54, v87
    v_fma_f32 v56, v116, v55, v56
    v_fma_f32 v88, v116, v87, v88
    v_fma_f32 v56, -v117, v87, v56
    v_fma_f32 v88, v117, v55, v88
    v_fma_f32 v57, v116, v56, v57
    v_fma_f32 v89, v116, v88, v89
    v_fma_f32 v57, -v117, v88, v57
    v_fma_f32 v89, v117, v56, v89
    v_fma_f32 v58, v116, v57, v58
    v_fma_f32 v90, v116, v89, v90
    v_fma_f32 v58, -v117, v89, v58
    v_fma_f32 v90, v117, v57, v90
    v_fma_f32 v59, v116, v58, v59
    v_fma_f32 v91, v116, v90, v91
    v_fma_f32 v59, -v117, v90, v59
    v_fma_f32 v91, v117, v58, v91
    v_cvt_pk_bf16_f32 v20, v52, v53
    v_cvt_pk_bf16_f32 v24, -v84, -v85
    v_cvt_pk_bf16_f32 v21, v54, v55
    v_cvt_pk_bf16_f32 v25, -v86, -v87
    v_cvt_pk_bf16_f32 v22, v56, v57
    v_cvt_pk_bf16_f32 v26, -v88, -v89
    v_cvt_pk_bf16_f32 v23, v58, v59
    v_cvt_pk_bf16_f32 v27, -v90, -v91
    buffer_store_dwordx4 v[20:23], v16, s[8:11], s35 offen sc1
    s_add_u32 s35, s35, 10240
    buffer_store_dwordx4 v[24:27], v16, s[8:11], s35 offen sc1
    s_add_u32 s35, s35, 11264
    v_fma_f32 v60, v116, v59, v60
    v_fma_f32 v92, v116, v91, v92
    v_fma_f32 v60, -v117, v91, v60
    v_fma_f32 v92, v117, v59, v92
    v_fma_f32 v61, v116, v60, v61
    v_fma_f32 v93, v116, v92, v93
    v_fma_f32 v61, -v117, v92, v61
    v_fma_f32 v93, v117, v60, v93
    v_fma_f32 v62, v116, v61, v62
    v_fma_f32 v94, v116, v93, v94
    v_fma_f32 v62, -v117, v93, v62
    v_fma_f32 v94, v117, v61, v94
    v_fma_f32 v63, v116, v62, v63
    v_fma_f32 v95, v116, v94, v95
    v_fma_f32 v63, -v117, v94, v63
    v_fma_f32 v95, v117, v62, v95
    v_fma_f32 v64, v116, v63, v64
    v_fma_f32 v96, v116, v95, v96
    v_fma_f32 v64, -v117, v95, v64
    v_fma_f32 v96, v117, v63, v96
    v_fma_f32 v65, v116, v64, v65
    v_fma_f32 v97, v116, v96, v97
    v_fma_f32 v65, -v117, v96, v65
    v_fma_f32 v97, v117, v64, v97
    v_fma_f32 v66, v116, v65, v66
    v_fma_f32 v98, v116, v97, v98
    v_fma_f32 v66, -v117, v97, v66
    v_fma_f32 v98, v117, v65, v98
    v_fma_f32 v67, v116, v66, v67
    v_fma_f32 v99, v116, v98, v99
    v_fma_f32 v67, -v117, v98, v67
    v_fma_f32 v99, v117, v66, v99
    v_cvt_pk_bf16_f32 v28, v60, v61
    v_cvt_pk_bf16_f32 v32, -v92, -v93
    v_cvt_pk_bf16_f32 v29, v62, v63
    v_cvt_pk_bf16_f32 v33, -v94, -v95
    v_cvt_pk_bf16_f32 v30, v64, v65
    v_cvt_pk_bf16_f32 v34, -v96, -v97
    v_cvt_pk_bf16_f32 v31, v66, v67
    v_cvt_pk_bf16_f32 v35, -v98, -v99
    buffer_store_dwordx4 v[28:31], v16, s[8:11], s35 offen sc1
    s_add_u32 s35, s35, 10240
    buffer_store_dwordx4 v[32:35], v16, s[8:11], s35 offen sc1
    s_add_u32 s35, s35, 11264
    v_fma_f32 v68, v116, v67, v68
    v_fma_f32 v100, v116, v99, v100
    v_fma_f32 v68, -v117, v99, v68
    v_fma_f32 v100, v117, v67, v100
    v_fma_f32 v69, v116, v68, v69
    v_fma_f32 v101, v116, v100, v101
    v_fma_f32 v69, -v117, v100, v69
    v_fma_f32 v101, v117, v68, v101
    v_fma_f32 v70, v116, v69, v70
    v_fma_f32 v102, v116, v101, v102
    v_fma_f32 v70, -v117, v101, v70
    v_fma_f32 v102, v117, v69, v102
    v_fma_f32 v71, v116, v70, v71
    v_fma_f32 v103, v116, v102, v103
    v_fma_f32 v71, -v117, v102, v71
    v_fma_f32 v103, v117, v70, v103
    v_fma_f32 v72, v116, v71, v72
    v_fma_f32 v104, v116, v103, v104
    v_fma_f32 v72, -v117, v103, v72
    v_fma_f32 v104, v117, v71, v104
    v_fma_f32 v73, v116, v72, v73
    v_fma_f32 v105, v116, v104, v105
    v_fma_f32 v73, -v117, v104, v73
    v_fma_f32 v105, v117, v72, v105
    v_fma_f32 v74, v116, v73, v74
    v_fma_f32 v106, v116, v105, v106
    v_fma_f32 v74, -v117, v105, v74
    v_fma_f32 v106, v117, v73, v106
    v_fma_f32 v75, v116, v74, v75
    v_fma_f32 v107, v116, v106, v107
    v_fma_f32 v75, -v117, v106, v75
    v_fma_f32 v107, v117, v74, v107
    v_cvt_pk_bf16_f32 v36, v68, v69
    v_cvt_pk_bf16_f32 v40, -v100, -v101
    v_cvt_pk_bf16_f32 v37, v70, v71
    v_cvt_pk_bf16_f32 v41, -v102, -v103
    v_cvt_pk_bf16_f32 v38, v72, v73
    v_cvt_pk_bf16_f32 v42, -v104, -v105
    v_cvt_pk_bf16_f32 v39, v74, v75
    v_cvt_pk_bf16_f32 v43, -v106, -v107
    buffer_store_dwordx4 v[36:39], v16, s[8:11], s35 offen sc1
    s_add_u32 s35, s35, 10240
    buffer_store_dwordx4 v[40:43], v16, s[8:11], s35 offen sc1
    s_add_u32 s35, s35, 11264
    v_fma_f32 v76, v116, v75, v76
    v_fma_f32 v108, v116, v107, v108
    v_fma_f32 v76, -v117, v107, v76
    v_fma_f32 v108, v117, v75, v108
    v_fma_f32 v77, v116, v76, v77
    v_fma_f32 v109, v116, v108, v109
    v_fma_f32 v77, -v117, v108, v77
    v_fma_f32 v109, v117, v76, v109
    v_fma_f32 v78, v116, v77, v78
    v_fma_f32 v110, v116, v109, v110
    v_fma_f32 v78, -v117, v109, v78
    v_fma_f32 v110, v117, v77, v110
    v_fma_f32 v79, v116, v78, v79
    v_fma_f32 v111, v116, v110, v111
    v_fma_f32 v79, -v117, v110, v79
    v_fma_f32 v111, v117, v78, v111
    v_fma_f32 v80, v116, v79, v80
    v_fma_f32 v112, v116, v111, v112
    v_fma_f32 v80, -v117, v111, v80
    v_fma_f32 v112, v117, v79, v112
    v_fma_f32 v81, v116, v80, v81
    v_fma_f32 v113, v116, v112, v113
    v_fma_f32 v81, -v117, v112, v81
    v_fma_f32 v113, v117, v80, v113
    v_fma_f32 v82, v116, v81, v82
    v_fma_f32 v114, v116, v113, v114
    v_fma_f32 v82, -v117, v113, v82
    v_fma_f32 v114, v117, v81, v114
    v_fma_f32 v83, v116, v82, v83
    v_fma_f32 v115, v116, v114, v115
    v_fma_f32 v83, -v117, v114, v83
    v_fma_f32 v115, v117, v82, v115
    v_cvt_pk_bf16_f32 v44, v76, v77
    v_cvt_pk_bf16_f32 v48, -v108, -v109
    v_cvt_pk_bf16_f32 v45, v78, v79
    v_cvt_pk_bf16_f32 v49, -v110, -v111
    v_cvt_pk_bf16_f32 v46, v80, v81
    v_cvt_pk_bf16_f32 v50, -v112, -v113
    v_cvt_pk_bf16_f32 v47, v82, v83
    v_cvt_pk_bf16_f32 v51, -v114, -v115
    buffer_store_dwordx4 v[44:47], v16, s[8:11], s35 offen sc1
    s_add_u32 s35, s35, 10240
    buffer_store_dwordx4 v[48:51], v16, s[8:11], s35 offen sc1
    s_add_u32 s35, s35, 11264
    s_mul_i32 s30, s12, 4864
    s_lshl_b32 s31, s13, 4
    s_add_u32 s30, s30, s31
    s_lshl_b32 s31, s14, 2
    s_add_u32 s30, s30, s31
    s_add_u32 s30, s30, 15990784
    s_waitcnt vmcnt(0)
    v_mov_b32 v4, 0
    v_mov_b32 v5, s80
    s_mov_b64 exec, 1
    buffer_store_dword v5, v4, s[8:11], s30 offen sc1
    s_mov_b64 exec, -1
    s_cmp_lg_u32 s14, 0
    s_cbranch_scc1 b_nc
    v_mov_b32 v126, 0
    v_mov_b32 v127, 1
    s_mov_b64 exec, 1
    buffer_atomic_add v127, v126, s[84:87], 0 offen sc1
    s_mov_b64 exec, -1
b_nc:
    s_branch c_end
c_y:
    s_lshl_b32 s12, s70, 1
    s_and_b32 s13, s71, 1
    s_add_u32 s12, s12, s13
    s_lshr_b32 s13, s71, 1
    s_load_dwordx2 s[24:25], s[0:1], 0
    s_load_dwordx2 s[26:27], s[0:1], 64
    v_lshrrev_b32 v120, 5, v2
    v_and_b32 v121, 31, v2
    s_lshl_b32 s34, s14, 4
    v_add_u32 v120, s34, v120
    v_mul_u32_u24 v116, 528, v120
    v_lshl_add_u32 v116, v121, 4, v116
    s_lshl_b32 s34, s12, 7
    v_add_u32 v120, s34, v120
    s_lshl_b32 s35, s13, 8
    v_lshl_add_u32 v119, v121, 3, s35
    v_mul_u32_u24 v117, 1280, v120
    v_add_u32 v117, v117, v119
    v_mul_u32_u24 v118, 5120, v120
    v_lshl_add_u32 v118, v119, 1, v118
    s_waitcnt lgkmcnt(0)
    global_load_dwordx2 v[124:125], v119, s[26:27]
    s_mov_b32 s76, s24
    s_and_b32 s77, s25, 0xffff
    s_mov_b32 s78, 0x280000
    s_mov_b32 s79, 0x00020000
    s_waitcnt vmcnt(0)
    v_lshlrev_b32 v120, 16, v124
    v_and_b32 v121, 0xffff0000, v124
    v_lshlrev_b32 v122, 16, v125
    v_and_b32 v123, 0xffff0000, v125
    v_bfe_u32 v20, v2, 4, 1
    v_bfe_u32 v21, v2, 1, 1
    v_lshl_add_u32 v20, v20, 1, v21
    v_bfe_u32 v21, v2, 2, 2
    v_lshrrev_b32 v22, 5, v2
    v_lshl_add_u32 v22, v22, 3, v21
    v_lshlrev_b32 v21, 2, v20
    v_xor_b32 v22, v22, v21
    v_lshlrev_b32 v22, 4, v22
    v_lshl_add_u32 v22, v20, 10, v22
    v_and_b32 v20, 1, v2
    v_lshl_add_u32 v22, v20, 3, v22
    s_mul_i32 s32, s28, 8192
    v_add_u32 v4, s32, v22
    v_xor_b32 v5, 64, v4
    v_and_b32 v20, 31, v2
    v_lshrrev_b32 v21, 5, v2
    v_bfe_u32 v22, v2, 1, 3
    v_xor_b32 v21, v21, v22
    v_lshlrev_b32 v21, 4, v21
    v_lshl_add_u32 v20, v20, 7, v21
    s_mul_i32 s32, s29, 8192
    v_add_u32 v6, s32, v20
    v_xor_b32 v7, 32, v6
    v_xor_b32 v8, 64, v6
    v_xor_b32 v9, 96, v6
    v_add_u32 v10, 49152, v4
    v_add_u32 v11, 49152, v5
    v_add_u32 v12, 49152, v6
    v_add_u32 v13, 49152, v7
    v_add_u32 v14, 49152, v8
    v_add_u32 v15, 49152, v9
    v_mov_b32 v52, 0
    v_mov_b32 v53, 0
    v_mov_b32 v54, 0
    v_mov_b32 v55, 0
    v_mov_b32 v56, 0
    v_mov_b32 v57, 0
    v_mov_b32 v58, 0
    v_mov_b32 v59, 0
    v_mov_b32 v60, 0
    v_mov_b32 v61, 0
    v_mov_b32 v62, 0
    v_mov_b32 v63, 0
    v_mov_b32 v64, 0
    v_mov_b32 v65, 0
    v_mov_b32 v66, 0
    v_mov_b32 v67, 0
    v_mov_b32 v68, 0
    v_mov_b32 v69, 0
    v_mov_b32 v70, 0
    v_mov_b32 v71, 0
    v_mov_b32 v72, 0
    v_mov_b32 v73, 0
    v_mov_b32 v74, 0
    v_mov_b32 v75, 0
    v_mov_b32 v76, 0
    v_mov_b32 v77, 0
    v_mov_b32 v78, 0
    v_mov_b32 v79, 0
    v_mov_b32 v80, 0
    v_mov_b32 v81, 0
    v_mov_b32 v82, 0
    v_mov_b32 v83, 0
    v_mov_b32 v84, 0
    v_mov_b32 v85, 0
    v_mov_b32 v86, 0
    v_mov_b32 v87, 0
    v_mov_b32 v88, 0
    v_mov_b32 v89, 0
    v_mov_b32 v90, 0
    v_mov_b32 v91, 0
    v_mov_b32 v92, 0
    v_mov_b32 v93, 0
    v_mov_b32 v94, 0
    v_mov_b32 v95, 0
    v_mov_b32 v96, 0
    v_mov_b32 v97, 0
    v_mov_b32 v98, 0
    v_mov_b32 v99, 0
    v_mov_b32 v100, 0
    v_mov_b32 v101, 0
    v_mov_b32 v102, 0
    v_mov_b32 v103, 0
    v_mov_b32 v104, 0
    v_mov_b32 v105, 0
    v_mov_b32 v106, 0
    v_mov_b32 v107, 0
    v_mov_b32 v108, 0
    v_mov_b32 v109, 0
    v_mov_b32 v110, 0
    v_mov_b32 v111, 0
    v_mov_b32 v112, 0
    v_mov_b32 v113, 0
    v_mov_b32 v114, 0
    v_mov_b32 v115, 0
    s_mul_i32 s32, s28, 33792
    s_lshl_b32 s33, s29, 8
    s_add_u32 s32, s32, s33
    v_and_b32 v126, 31, v2
    v_lshrrev_b32 v127, 5, v2
    v_mul_u32_u24 v126, 528, v126
    v_lshl_add_u32 v126, v127, 6, v126
    v_add_u32 v126, s32, v126
    s_setprio 0
    s_barrier
    s_barrier
    ds_read_b128 v[28:31], v6 offset:16384
    ds_read_b64_tr_b16 v[20:21], v4 offset:0
    ds_read_b64_tr_b16 v[22:23], v5 offset:0
    ds_read_b64_tr_b16 v[24:25], v4 offset:4096
    ds_read_b64_tr_b16 v[26:27], v5 offset:4096
    ds_read_b128 v[32:35], v6 offset:20480
    ds_read_b128 v[44:47], v7 offset:16384
    ds_read_b64_tr_b16 v[36:37], v4 offset:256
    ds_read_b64_tr_b16 v[38:39], v5 offset:256
    ds_read_b64_tr_b16 v[40:41], v4 offset:4352
    ds_read_b64_tr_b16 v[42:43], v5 offset:4352
    ds_read_b128 v[48:51], v7 offset:20480
    s_waitcnt lgkmcnt(0)
    s_mov_b32 s32, 0
.p2align 3
y_loop:
    s_waitcnt lgkmcnt(9)
    v_mfma_f32_32x32x16_bf16 v[52:67], v[28:31], v[20:23], v[52:67]
    s_waitcnt lgkmcnt(7)
    v_mfma_f32_32x32x16_bf16 v[68:83], v[28:31], v[24:27], v[68:83]
    ds_read_b128 v[28:31], v8 offset:16384
    s_waitcnt lgkmcnt(7)
    v_mfma_f32_32x32x16_bf16 v[84:99], v[32:35], v[20:23], v[84:99]
    ds_read_b64_tr_b16 v[20:21], v4 offset:512
    ds_read_b64_tr_b16 v[22:23], v5 offset:512
    v_mfma_f32_32x32x16_bf16 v[100:115], v[32:35], v[24:27], v[100:115]
    ds_read_b64_tr_b16 v[24:25], v4 offset:4608
    ds_read_b64_tr_b16 v[26:27], v5 offset:4608
    ds_read_b128 v[32:35], v8 offset:20480
    s_waitcnt lgkmcnt(9)
    v_mfma_f32_32x32x16_bf16 v[52:67], v[44:47], v[36:39], v[52:67]
    s_waitcnt lgkmcnt(7)
    v_mfma_f32_32x32x16_bf16 v[68:83], v[44:47], v[40:43], v[68:83]
    ds_read_b128 v[44:47], v9 offset:16384
    s_waitcnt lgkmcnt(7)
    v_mfma_f32_32x32x16_bf16 v[84:99], v[48:51], v[36:39], v[84:99]
    ds_read_b64_tr_b16 v[36:37], v4 offset:768
    ds_read_b64_tr_b16 v[38:39], v5 offset:768
    v_mfma_f32_32x32x16_bf16 v[100:115], v[48:51], v[40:43], v[100:115]
    ds_read_b64_tr_b16 v[40:41], v4 offset:4864
    ds_read_b64_tr_b16 v[42:43], v5 offset:4864
    ds_read_b128 v[48:51], v9 offset:20480
    s_waitcnt lgkmcnt(9)
    v_mfma_f32_32x32x16_bf16 v[52:67], v[28:31], v[20:23], v[52:67]
    s_waitcnt lgkmcnt(7)
    v_mfma_f32_32x32x16_bf16 v[68:83], v[28:31], v[24:27], v[68:83]
    s_waitcnt lgkmcnt(0)
    s_barrier
    ds_read_b128 v[28:31], v12 offset:0
    v_mfma_f32_32x32x16_bf16 v[84:99], v[32:35], v[20:23], v[84:99]
    ds_read_b64_tr_b16 v[20:21], v4 offset:32768
    ds_read_b64_tr_b16 v[22:23], v5 offset:32768
    v_mfma_f32_32x32x16_bf16 v[100:115], v[32:35], v[24:27], v[100:115]
    ds_read_b64_tr_b16 v[24:25], v4 offset:36864
    ds_read_b64_tr_b16 v[26:27], v5 offset:36864
    ds_read_b128 v[32:35], v12 offset:4096
    v_mfma_f32_32x32x16_bf16 v[52:67], v[44:47], v[36:39], v[52:67]
    v_mfma_f32_32x32x16_bf16 v[68:83], v[44:47], v[40:43], v[68:83]
    ds_read_b128 v[44:47], v13 offset:0
    v_mfma_f32_32x32x16_bf16 v[84:99], v[48:51], v[36:39], v[84:99]
    ds_read_b64_tr_b16 v[36:37], v4 offset:33024
    ds_read_b64_tr_b16 v[38:39], v5 offset:33024
    v_mfma_f32_32x32x16_bf16 v[100:115], v[48:51], v[40:43], v[100:115]
    ds_read_b64_tr_b16 v[40:41], v4 offset:37120
    ds_read_b64_tr_b16 v[42:43], v5 offset:37120
    ds_read_b128 v[48:51], v13 offset:4096
    s_waitcnt lgkmcnt(9)
    v_mfma_f32_32x32x16_bf16 v[52:67], v[28:31], v[20:23], v[52:67]
    s_waitcnt lgkmcnt(7)
    v_mfma_f32_32x32x16_bf16 v[68:83], v[28:31], v[24:27], v[68:83]
    ds_read_b128 v[28:31], v14 offset:0
    s_waitcnt lgkmcnt(7)
    v_mfma_f32_32x32x16_bf16 v[84:99], v[32:35], v[20:23], v[84:99]
    ds_read_b64_tr_b16 v[20:21], v4 offset:33280
    ds_read_b64_tr_b16 v[22:23], v5 offset:33280
    v_mfma_f32_32x32x16_bf16 v[100:115], v[32:35], v[24:27], v[100:115]
    ds_read_b64_tr_b16 v[24:25], v4 offset:37376
    ds_read_b64_tr_b16 v[26:27], v5 offset:37376
    ds_read_b128 v[32:35], v14 offset:4096
    s_waitcnt lgkmcnt(9)
    v_mfma_f32_32x32x16_bf16 v[52:67], v[44:47], v[36:39], v[52:67]
    s_waitcnt lgkmcnt(7)
    v_mfma_f32_32x32x16_bf16 v[68:83], v[44:47], v[40:43], v[68:83]
    ds_read_b128 v[44:47], v15 offset:0
    s_waitcnt lgkmcnt(7)
    v_mfma_f32_32x32x16_bf16 v[84:99], v[48:51], v[36:39], v[84:99]
    ds_read_b64_tr_b16 v[36:37], v4 offset:33536
    ds_read_b64_tr_b16 v[38:39], v5 offset:33536
    v_mfma_f32_32x32x16_bf16 v[100:115], v[48:51], v[40:43], v[100:115]
    ds_read_b64_tr_b16 v[40:41], v4 offset:37632
    ds_read_b64_tr_b16 v[42:43], v5 offset:37632
    ds_read_b128 v[48:51], v15 offset:4096
    s_waitcnt lgkmcnt(9)
    v_mfma_f32_32x32x16_bf16 v[52:67], v[28:31], v[20:23], v[52:67]
    s_waitcnt lgkmcnt(7)
    v_mfma_f32_32x32x16_bf16 v[68:83], v[28:31], v[24:27], v[68:83]
    s_waitcnt lgkmcnt(0)
    s_barrier
    ds_read_b128 v[28:31], v6 offset:0
    v_mfma_f32_32x32x16_bf16 v[84:99], v[32:35], v[20:23], v[84:99]
    ds_read_b64_tr_b16 v[20:21], v10 offset:16384
    ds_read_b64_tr_b16 v[22:23], v11 offset:16384
    v_mfma_f32_32x32x16_bf16 v[100:115], v[32:35], v[24:27], v[100:115]
    ds_read_b64_tr_b16 v[24:25], v10 offset:20480
    ds_read_b64_tr_b16 v[26:27], v11 offset:20480
    ds_read_b128 v[32:35], v6 offset:4096
    v_mfma_f32_32x32x16_bf16 v[52:67], v[44:47], v[36:39], v[52:67]
    v_mfma_f32_32x32x16_bf16 v[68:83], v[44:47], v[40:43], v[68:83]
    ds_read_b128 v[44:47], v7 offset:0
    v_mfma_f32_32x32x16_bf16 v[84:99], v[48:51], v[36:39], v[84:99]
    ds_read_b64_tr_b16 v[36:37], v10 offset:16640
    ds_read_b64_tr_b16 v[38:39], v11 offset:16640
    v_mfma_f32_32x32x16_bf16 v[100:115], v[48:51], v[40:43], v[100:115]
    ds_read_b64_tr_b16 v[40:41], v10 offset:20736
    ds_read_b64_tr_b16 v[42:43], v11 offset:20736
    ds_read_b128 v[48:51], v7 offset:4096
    s_waitcnt lgkmcnt(9)
    v_mfma_f32_32x32x16_bf16 v[52:67], v[28:31], v[20:23], v[52:67]
    s_waitcnt lgkmcnt(7)
    v_mfma_f32_32x32x16_bf16 v[68:83], v[28:31], v[24:27], v[68:83]
    ds_read_b128 v[28:31], v8 offset:0
    s_waitcnt lgkmcnt(7)
    v_mfma_f32_32x32x16_bf16 v[84:99], v[32:35], v[20:23], v[84:99]
    ds_read_b64_tr_b16 v[20:21], v10 offset:16896
    ds_read_b64_tr_b16 v[22:23], v11 offset:16896
    v_mfma_f32_32x32x16_bf16 v[100:115], v[32:35], v[24:27], v[100:115]
    ds_read_b64_tr_b16 v[24:25], v10 offset:20992
    ds_read_b64_tr_b16 v[26:27], v11 offset:20992
    ds_read_b128 v[32:35], v8 offset:4096
    s_waitcnt lgkmcnt(9)
    v_mfma_f32_32x32x16_bf16 v[52:67], v[44:47], v[36:39], v[52:67]
    s_waitcnt lgkmcnt(7)
    v_mfma_f32_32x32x16_bf16 v[68:83], v[44:47], v[40:43], v[68:83]
    ds_read_b128 v[44:47], v9 offset:0
    s_waitcnt lgkmcnt(7)
    v_mfma_f32_32x32x16_bf16 v[84:99], v[48:51], v[36:39], v[84:99]
    ds_read_b64_tr_b16 v[36:37], v10 offset:17152
    ds_read_b64_tr_b16 v[38:39], v11 offset:17152
    v_mfma_f32_32x32x16_bf16 v[100:115], v[48:51], v[40:43], v[100:115]
    ds_read_b64_tr_b16 v[40:41], v10 offset:21248
    ds_read_b64_tr_b16 v[42:43], v11 offset:21248
    ds_read_b128 v[48:51], v9 offset:4096
    s_waitcnt lgkmcnt(9)
    v_mfma_f32_32x32x16_bf16 v[52:67], v[28:31], v[20:23], v[52:67]
    s_waitcnt lgkmcnt(7)
    v_mfma_f32_32x32x16_bf16 v[68:83], v[28:31], v[24:27], v[68:83]
    s_waitcnt lgkmcnt(0)
    s_barrier
    ds_read_b128 v[28:31], v6 offset:32768
    v_mfma_f32_32x32x16_bf16 v[84:99], v[32:35], v[20:23], v[84:99]
    ds_read_b64_tr_b16 v[20:21], v4 offset:16384
    ds_read_b64_tr_b16 v[22:23], v5 offset:16384
    v_mfma_f32_32x32x16_bf16 v[100:115], v[32:35], v[24:27], v[100:115]
    ds_read_b64_tr_b16 v[24:25], v4 offset:20480
    ds_read_b64_tr_b16 v[26:27], v5 offset:20480
    ds_read_b128 v[32:35], v6 offset:36864
    v_mfma_f32_32x32x16_bf16 v[52:67], v[44:47], v[36:39], v[52:67]
    v_mfma_f32_32x32x16_bf16 v[68:83], v[44:47], v[40:43], v[68:83]
    ds_read_b128 v[44:47], v7 offset:32768
    v_mfma_f32_32x32x16_bf16 v[84:99], v[48:51], v[36:39], v[84:99]
    ds_read_b64_tr_b16 v[36:37], v4 offset:16640
    ds_read_b64_tr_b16 v[38:39], v5 offset:16640
    v_mfma_f32_32x32x16_bf16 v[100:115], v[48:51], v[40:43], v[100:115]
    ds_read_b64_tr_b16 v[40:41], v4 offset:20736
    ds_read_b64_tr_b16 v[42:43], v5 offset:20736
    ds_read_b128 v[48:51], v7 offset:36864
    s_waitcnt lgkmcnt(9)
    v_mfma_f32_32x32x16_bf16 v[52:67], v[28:31], v[20:23], v[52:67]
    s_waitcnt lgkmcnt(7)
    v_mfma_f32_32x32x16_bf16 v[68:83], v[28:31], v[24:27], v[68:83]
    ds_read_b128 v[28:31], v8 offset:32768
    s_waitcnt lgkmcnt(7)
    v_mfma_f32_32x32x16_bf16 v[84:99], v[32:35], v[20:23], v[84:99]
    ds_read_b64_tr_b16 v[20:21], v4 offset:16896
    ds_read_b64_tr_b16 v[22:23], v5 offset:16896
    v_mfma_f32_32x32x16_bf16 v[100:115], v[32:35], v[24:27], v[100:115]
    ds_read_b64_tr_b16 v[24:25], v4 offset:20992
    ds_read_b64_tr_b16 v[26:27], v5 offset:20992
    ds_read_b128 v[32:35], v8 offset:36864
    s_waitcnt lgkmcnt(9)
    v_mfma_f32_32x32x16_bf16 v[52:67], v[44:47], v[36:39], v[52:67]
    s_waitcnt lgkmcnt(7)
    v_mfma_f32_32x32x16_bf16 v[68:83], v[44:47], v[40:43], v[68:83]
    ds_read_b128 v[44:47], v9 offset:32768
    s_waitcnt lgkmcnt(7)
    v_mfma_f32_32x32x16_bf16 v[84:99], v[48:51], v[36:39], v[84:99]
    ds_read_b64_tr_b16 v[36:37], v4 offset:17152
    ds_read_b64_tr_b16 v[38:39], v5 offset:17152
    v_mfma_f32_32x32x16_bf16 v[100:115], v[48:51], v[40:43], v[100:115]
    ds_read_b64_tr_b16 v[40:41], v4 offset:21248
    ds_read_b64_tr_b16 v[42:43], v5 offset:21248
    ds_read_b128 v[48:51], v9 offset:36864
    s_waitcnt lgkmcnt(9)
    v_mfma_f32_32x32x16_bf16 v[52:67], v[28:31], v[20:23], v[52:67]
    s_waitcnt lgkmcnt(7)
    v_mfma_f32_32x32x16_bf16 v[68:83], v[28:31], v[24:27], v[68:83]
    s_waitcnt lgkmcnt(0)
    s_barrier
    ds_read_b128 v[28:31], v12 offset:16384
    v_mfma_f32_32x32x16_bf16 v[84:99], v[32:35], v[20:23], v[84:99]
    ds_read_b64_tr_b16 v[20:21], v10 offset:0
    ds_read_b64_tr_b16 v[22:23], v11 offset:0
    v_mfma_f32_32x32x16_bf16 v[100:115], v[32:35], v[24:27], v[100:115]
    ds_read_b64_tr_b16 v[24:25], v10 offset:4096
    ds_read_b64_tr_b16 v[26:27], v11 offset:4096
    ds_read_b128 v[32:35], v12 offset:20480
    v_mfma_f32_32x32x16_bf16 v[52:67], v[44:47], v[36:39], v[52:67]
    v_mfma_f32_32x32x16_bf16 v[68:83], v[44:47], v[40:43], v[68:83]
    ds_read_b128 v[44:47], v13 offset:16384
    v_mfma_f32_32x32x16_bf16 v[84:99], v[48:51], v[36:39], v[84:99]
    ds_read_b64_tr_b16 v[36:37], v10 offset:256
    ds_read_b64_tr_b16 v[38:39], v11 offset:256
    v_mfma_f32_32x32x16_bf16 v[100:115], v[48:51], v[40:43], v[100:115]
    ds_read_b64_tr_b16 v[40:41], v10 offset:4352
    ds_read_b64_tr_b16 v[42:43], v11 offset:4352
    ds_read_b128 v[48:51], v13 offset:20480
    s_waitcnt lgkmcnt(9)
    v_mfma_f32_32x32x16_bf16 v[52:67], v[28:31], v[20:23], v[52:67]
    s_waitcnt lgkmcnt(7)
    v_mfma_f32_32x32x16_bf16 v[68:83], v[28:31], v[24:27], v[68:83]
    ds_read_b128 v[28:31], v14 offset:16384
    s_waitcnt lgkmcnt(7)
    v_mfma_f32_32x32x16_bf16 v[84:99], v[32:35], v[20:23], v[84:99]
    ds_read_b64_tr_b16 v[20:21], v10 offset:512
    ds_read_b64_tr_b16 v[22:23], v11 offset:512
    v_mfma_f32_32x32x16_bf16 v[100:115], v[32:35], v[24:27], v[100:115]
    ds_read_b64_tr_b16 v[24:25], v10 offset:4608
    ds_read_b64_tr_b16 v[26:27], v11 offset:4608
    ds_read_b128 v[32:35], v14 offset:20480
    s_waitcnt lgkmcnt(9)
    v_mfma_f32_32x32x16_bf16 v[52:67], v[44:47], v[36:39], v[52:67]
    s_waitcnt lgkmcnt(7)
    v_mfma_f32_32x32x16_bf16 v[68:83], v[44:47], v[40:43], v[68:83]
    ds_read_b128 v[44:47], v15 offset:16384
    s_waitcnt lgkmcnt(7)
    v_mfma_f32_32x32x16_bf16 v[84:99], v[48:51], v[36:39], v[84:99]
    ds_read_b64_tr_b16 v[36:37], v10 offset:768
    ds_read_b64_tr_b16 v[38:39], v11 offset:768
    v_mfma_f32_32x32x16_bf16 v[100:115], v[48:51], v[40:43], v[100:115]
    ds_read_b64_tr_b16 v[40:41], v10 offset:4864
    ds_read_b64_tr_b16 v[42:43], v11 offset:4864
    ds_read_b128 v[48:51], v15 offset:20480
    s_waitcnt lgkmcnt(9)
    v_mfma_f32_32x32x16_bf16 v[52:67], v[28:31], v[20:23], v[52:67]
    s_waitcnt lgkmcnt(7)
    v_mfma_f32_32x32x16_bf16 v[68:83], v[28:31], v[24:27], v[68:83]
    s_waitcnt lgkmcnt(0)
    s_barrier
    ds_read_b128 v[28:31], v6 offset:16384
    v_mfma_f32_32x32x16_bf16 v[84:99], v[32:35], v[20:23], v[84:99]
    ds_read_b64_tr_b16 v[20:21], v4 offset:0
    ds_read_b64_tr_b16 v[22:23], v5 offset:0
    v_mfma_f32_32x32x16_bf16 v[100:115], v[32:35], v[24:27], v[100:115]
    ds_read_b64_tr_b16 v[24:25], v4 offset:4096
    ds_read_b64_tr_b16 v[26:27], v5 offset:4096
    ds_read_b128 v[32:35], v6 offset:20480
    v_mfma_f32_32x32x16_bf16 v[52:67], v[44:47], v[36:39], v[52:67]
    v_mfma_f32_32x32x16_bf16 v[68:83], v[44:47], v[40:43], v[68:83]
    ds_read_b128 v[44:47], v7 offset:16384
    v_mfma_f32_32x32x16_bf16 v[84:99], v[48:51], v[36:39], v[84:99]
    ds_read_b64_tr_b16 v[36:37], v4 offset:256
    ds_read_b64_tr_b16 v[38:39], v5 offset:256
    v_mfma_f32_32x32x16_bf16 v[100:115], v[48:51], v[40:43], v[100:115]
    ds_read_b64_tr_b16 v[40:41], v4 offset:4352
    ds_read_b64_tr_b16 v[42:43], v5 offset:4352
    ds_read_b128 v[48:51], v7 offset:20480
    s_add_u32 s32, s32, 1
    s_cmp_lt_u32 s32, 4
    s_cbranch_scc1 y_loop
    s_waitcnt lgkmcnt(0)
    s_setprio 3
    buffer_load_dwordx2 v[20:21], v117, s[76:79], 0 offen
    s_mov_b32 s33, 2560
    buffer_load_dwordx2 v[22:23], v117, s[76:79], s33 offen
    s_mov_b32 s33, 5120
    buffer_load_dwordx2 v[24:25], v117, s[76:79], s33 offen
    s_mov_b32 s33, 7680
    buffer_load_dwordx2 v[26:27], v117, s[76:79], s33 offen
    s_mov_b32 s33, 10240
    buffer_load_dwordx2 v[28:29], v117, s[76:79], s33 offen
    s_mov_b32 s33, 12800
    buffer_load_dwordx2 v[30:31], v117, s[76:79], s33 offen
    s_mov_b32 s33, 15360
    buffer_load_dwordx2 v[32:33], v117, s[76:79], s33 offen
    s_mov_b32 s33, 17920
    buffer_load_dwordx2 v[34:35], v117, s[76:79], s33 offen
    ds_write_b128 v126, v[52:55] offset:0
    ds_write_b128 v126, v[56:59] offset:16
    ds_write_b128 v126, v[60:63] offset:32
    ds_write_b128 v126, v[64:67] offset:48
    ds_write_b128 v126, v[68:71] offset:16896
    ds_write_b128 v126, v[72:75] offset:16912
    ds_write_b128 v126, v[76:79] offset:16928
    ds_write_b128 v126, v[80:83] offset:16944
    ds_write_b128 v126, v[84:87] offset:128
    ds_write_b128 v126, v[88:91] offset:144
    ds_write_b128 v126, v[92:95] offset:160
    ds_write_b128 v126, v[96:99] offset:176
    ds_write_b128 v126, v[100:103] offset:17024
    ds_write_b128 v126, v[104:107] offset:17040
    ds_write_b128 v126, v[108:111] offset:17056
    ds_write_b128 v126, v[112:115] offset:17072
    s_waitcnt lgkmcnt(0)
    s_barrier
    ds_read_b128 v[52:55], v116 offset:0
    ds_read_b128 v[56:59], v116 offset:1056
    ds_read_b128 v[60:63], v116 offset:2112
    ds_read_b128 v[64:67], v116 offset:3168
    ds_read_b128 v[68:71], v116 offset:4224
    ds_read_b128 v[72:75], v116 offset:5280
    ds_read_b128 v[76:79], v116 offset:6336
    ds_read_b128 v[80:83], v116 offset:7392
    s_mov_b32 s33, 0
    s_waitcnt vmcnt(7) lgkmcnt(7)
    v_lshlrev_b32 v5, 16, v20
    v_and_b32 v6, 0xffff0000, v20
    v_fmac_f32 v52, v5, v120
    v_fmac_f32 v53, v6, v121
    v_lshlrev_b32 v5, 16, v21
    v_and_b32 v6, 0xffff0000, v21
    v_fmac_f32 v54, v5, v122
    v_fmac_f32 v55, v6, v123
    buffer_store_dwordx4 v[52:55], v118, s[92:95], s33 offen sc1 nt
    s_add_u32 s33, s33, 10240
    s_waitcnt vmcnt(7) lgkmcnt(6)
    v_lshlrev_b32 v5, 16, v22
    v_and_b32 v6, 0xffff0000, v22
    v_fmac_f32 v56, v5, v120
    v_fmac_f32 v57, v6, v121
    v_lshlrev_b32 v5, 16, v23
    v_and_b32 v6, 0xffff0000, v23
    v_fmac_f32 v58, v5, v122
    v_fmac_f32 v59, v6, v123
    buffer_store_dwordx4 v[56:59], v118, s[92:95], s33 offen sc1 nt
    s_add_u32 s33, s33, 10240
    s_waitcnt vmcnt(7) lgkmcnt(5)
    v_lshlrev_b32 v5, 16, v24
    v_and_b32 v6, 0xffff0000, v24
    v_fmac_f32 v60, v5, v120
    v_fmac_f32 v61, v6, v121
    v_lshlrev_b32 v5, 16, v25
    v_and_b32 v6, 0xffff0000, v25
    v_fmac_f32 v62, v5, v122
    v_fmac_f32 v63, v6, v123
    buffer_store_dwordx4 v[60:63], v118, s[92:95], s33 offen sc1 nt
    s_add_u32 s33, s33, 10240
    s_waitcnt vmcnt(7) lgkmcnt(4)
    v_lshlrev_b32 v5, 16, v26
    v_and_b32 v6, 0xffff0000, v26
    v_fmac_f32 v64, v5, v120
    v_fmac_f32 v65, v6, v121
    v_lshlrev_b32 v5, 16, v27
    v_and_b32 v6, 0xffff0000, v27
    v_fmac_f32 v66, v5, v122
    v_fmac_f32 v67, v6, v123
    buffer_store_dwordx4 v[64:67], v118, s[92:95], s33 offen sc1 nt
    s_add_u32 s33, s33, 10240
    s_waitcnt vmcnt(7) lgkmcnt(3)
    v_lshlrev_b32 v5, 16, v28
    v_and_b32 v6, 0xffff0000, v28
    v_fmac_f32 v68, v5, v120
    v_fmac_f32 v69, v6, v121
    v_lshlrev_b32 v5, 16, v29
    v_and_b32 v6, 0xffff0000, v29
    v_fmac_f32 v70, v5, v122
    v_fmac_f32 v71, v6, v123
    buffer_store_dwordx4 v[68:71], v118, s[92:95], s33 offen sc1 nt
    s_add_u32 s33, s33, 10240
    s_waitcnt vmcnt(7) lgkmcnt(2)
    v_lshlrev_b32 v5, 16, v30
    v_and_b32 v6, 0xffff0000, v30
    v_fmac_f32 v72, v5, v120
    v_fmac_f32 v73, v6, v121
    v_lshlrev_b32 v5, 16, v31
    v_and_b32 v6, 0xffff0000, v31
    v_fmac_f32 v74, v5, v122
    v_fmac_f32 v75, v6, v123
    buffer_store_dwordx4 v[72:75], v118, s[92:95], s33 offen sc1 nt
    s_add_u32 s33, s33, 10240
    s_waitcnt vmcnt(7) lgkmcnt(1)
    v_lshlrev_b32 v5, 16, v32
    v_and_b32 v6, 0xffff0000, v32
    v_fmac_f32 v76, v5, v120
    v_fmac_f32 v77, v6, v121
    v_lshlrev_b32 v5, 16, v33
    v_and_b32 v6, 0xffff0000, v33
    v_fmac_f32 v78, v5, v122
    v_fmac_f32 v79, v6, v123
    buffer_store_dwordx4 v[76:79], v118, s[92:95], s33 offen sc1 nt
    s_add_u32 s33, s33, 10240
    s_waitcnt vmcnt(7) lgkmcnt(0)
    v_lshlrev_b32 v5, 16, v34
    v_and_b32 v6, 0xffff0000, v34
    v_fmac_f32 v80, v5, v120
    v_fmac_f32 v81, v6, v121
    v_lshlrev_b32 v5, 16, v35
    v_and_b32 v6, 0xffff0000, v35
    v_fmac_f32 v82, v5, v122
    v_fmac_f32 v83, v6, v123
    buffer_store_dwordx4 v[80:83], v118, s[92:95], s33 offen sc1 nt
c_end:
    s_cmp_lg_u32 s14, 0
    s_cbranch_scc1 c_fin
    s_cmp_lg_u32 s2, 511
    s_cbranch_scc1 c_fin
    s_mov_b32 s30, 0
    v_mov_b32 v4, 0
c_ep:
    buffer_load_dword v5, v4, s[84:87], 0 offen sc1
    s_add_u32 s30, s30, 1
    s_waitcnt vmcnt(0)
    v_readfirstlane_b32 s31, v5
    s_nop 0
    s_cmp_ge_u32 s31, 512
    s_cbranch_scc1 c_ep_d
    s_sleep 40
    s_cmp_lt_u32 s30, 200000
    s_cbranch_scc1 c_ep
c_ep_d:
    s_mov_b32 s30, 12517376
    v_mov_b32 v4, 0
    v_mov_b32 v5, s80
    s_mov_b64 exec, 1
    buffer_store_dword v5, v4, s[8:11], s30 offen sc1
    s_mov_b64 exec, -1
c_fin:
    s_endpgm
s_idle:
    s_bitcmp1_b32 s71, 0
    s_cbranch_scc1 ct_skip
    s_getpc_b64 s[30:31]
ct_a:
    s_sub_u32 s30, s30, ct_a-concat_heads__ssm_conv_s5__softmax_full_mha__prompt_kernel
    s_subb_u32 s31, s31, 0
    v_lshlrev_b32 v18, 7, v0
    v_min_u32 v18, m_exit-concat_heads__ssm_conv_s5__softmax_full_mha__prompt_kernel, v18
    v_mov_b32 v19, s31
    v_add_co_u32 v18, vcc, s30, v18
    s_nop 1
    v_addc_co_u32 v19, vcc, 0, v19, vcc
    global_load_dword v20, v[18:19], off
    s_waitcnt vmcnt(0)
ct_skip:
    s_load_dwordx2 s[20:21], s[0:1], 88
    v_lshlrev_b32 v16, 7, v2
    s_sub_u32 s34, s2, 336
    s_lshl_b32 s34, s34, 3
    s_add_u32 s34, s34, s14
    s_mul_i32 s34, s34, 6400
    s_waitcnt lgkmcnt(0)
    s_mov_b32 s36, s20
    s_and_b32 s37, s21, 0xffff
    s_mov_b32 s38, 0xc8000
    s_mov_b32 s39, 0x00020000
    s_sleep 110
    s_sleep 110
    s_sleep 110
    s_sleep 110
    s_sleep 110
    s_mov_b32 exec_hi, 0x3ffff
    buffer_load_dword v17, v16, s[36:39], s34 offen
    s_mov_b64 exec, -1
    s_waitcnt vmcnt(0)
    s_cmp_lg_u32 s14, 0
    s_cbranch_scc1 i_nc
    v_mov_b32 v4, 0
    v_mov_b32 v5, 1
    s_mov_b64 exec, 1
    buffer_atomic_add v5, v4, s[84:87], 0 offen sc1
    s_mov_b64 exec, -1
i_nc:
    s_bitcmp1_b32 s71, 0
    s_cbranch_scc0 m_exit
    s_getpc_b64 s[30:31]
ct_b:
    s_sub_u32 s30, s30, ct_b-concat_heads__ssm_conv_s5__softmax_full_mha__prompt_kernel
    s_subb_u32 s31, s31, 0
    v_lshlrev_b32 v18, 7, v0
    v_min_u32 v18, m_exit-concat_heads__ssm_conv_s5__softmax_full_mha__prompt_kernel, v18
    v_mov_b32 v19, s31
    v_add_co_u32 v18, vcc, s30, v18
    s_nop 1
    v_addc_co_u32 v19, vcc, 0, v19, vcc
    global_load_dword v20, v[18:19], off
    s_waitcnt vmcnt(0)
m_exit:
    s_endpgm
.section .rodata,"a"
.p2align 6
.amdhsa_kernel concat_heads__ssm_conv_s5__softmax_full_mha__prompt_kernel
  .amdhsa_next_free_vgpr 128
  .amdhsa_next_free_sgpr 96
  .amdhsa_accum_offset 128
  .amdhsa_group_segment_fixed_size 0
  .amdhsa_kernarg_size 120
  .amdhsa_user_sgpr_count 2
  .amdhsa_user_sgpr_kernarg_segment_ptr 1
  .amdhsa_system_sgpr_workgroup_id_x 1
.end_amdhsa_kernel
```
